```python
import torch

def _softmax(x, axis=-1):
    return torch.softmax(x, dim=axis)
def _gelu(x):
    return torch.nn.functional.gelu(x, approximate="tanh")
def _silu(x):
    return torch.nn.functional.silu(x)
def _sigmoid(x):
    return torch.sigmoid(x)
def _layernorm(x, axis=-1, eps=1e-5):
    m = x.mean(dim=axis, keepdim=True)
    v = x.var(dim=axis, keepdim=True, unbiased=False)
    return (x - m) / torch.sqrt(v + eps)
def _scatter_add(tgt, idx, src, axis=0):
    return tgt.clone().index_add_(axis, idx, src)
def _segment_sum(src, seg, n):
    out = torch.zeros((n,) + src.shape[1:], dtype=src.dtype)
    return out.index_add_(0, seg, src)
def _pad(x, pw):
    flat = tuple(v for pair in reversed(pw) for v in pair)
    return torch.nn.functional.pad(x, flat)

kernel_name = 'recurrent_scan__mha_block__moe_arch_mod__prompt'

def setup_inputs():

    _w = (lambda a: (lambda t: t.to(torch.bfloat16) if t.is_floating_point() else t)(torch.as_tensor(a)))
    def _A_setup():
        B, S, D, H = 1, 2048, 512, 32
        return {
            "x": _w((lambda *s: torch.randn(*s, dtype=torch.bfloat16) * 0.05)(B, S, D)),
            "wqkv": _w((lambda *s: torch.randn(*s, dtype=torch.bfloat16) * 0.05)(D, 3 * D)),
            "wo": _w((lambda *s: torch.randn(*s, dtype=torch.bfloat16) * 0.05)(D, D)),
        }
    _A_in = _A_setup()

    def _B_setup():
        B, S, D, F, C = 1, 2048, 512, 1792, 8
        return {
            "x": _w((lambda *s: torch.randn(*s, dtype=torch.bfloat16) * 0.05)(B, S, D)),
            "w_r": _w((lambda *s: torch.randn(*s, dtype=torch.bfloat16) * 0.05)(D)),
            "w_gate": _w((lambda *s: torch.randn(*s, dtype=torch.bfloat16) * 0.05)(D, F)),
            "w_up": _w((lambda *s: torch.randn(*s, dtype=torch.bfloat16) * 0.05)(D, F)),
            "w_down": _w((lambda *s: torch.randn(*s, dtype=torch.bfloat16) * 0.05)(F, D)),
        }
    _B_in = _B_setup()

    return {
        "A_x": _A_in["x"],
        "A_wqkv": _A_in["wqkv"],
        "A_wo": _A_in["wo"],
        "B_x": _B_in["x"],
        "B_w_r": _B_in["w_r"],
        "B_w_gate": _B_in["w_gate"],
        "B_w_up": _B_in["w_up"],
        "B_w_down": _B_in["w_down"],
    }

def reference(A_x, A_wqkv, A_wo, B_x, B_w_r, B_w_gate, B_w_up, B_w_down):
    def _A_ref(x, wqkv, wo):
        B, S, D = x.shape
        H = 32
        Dh = D // H
        qkv = (lambda x, *d: x.permute(*d))((x @ wqkv).reshape(B, S, 3, H, Dh), 2, 0, 3, 1, 4)
        q, k, v = qkv[0], qkv[1], qkv[2]
        scores = torch.einsum("bhqd,bhkd->bhqk", q, k) * (Dh ** -0.5)
        p = _softmax(scores, axis=-1)
        o = torch.einsum("bhqk,bhkd->bhqd", p, v)
        return (lambda x, *d: x.permute(*d))(o, 0, 2, 1, 3).reshape(B, S, D) @ wo

    def _B_ref(x, w_r, w_gate, w_up, w_down):
        B, S, D = x.shape
        C = 8
        r = x @ w_r
        idx = torch.argsort(-r, axis=-1)[:, :C]
        idx_e = (lambda x, n, axis: torch.repeat_interleave(x, n, dim=axis))(idx.reshape(B, C, 1), D, axis=2)
        x_sel = (lambda x, i, axis: torch.take_along_dim(x, i, dim=axis))(x, idx_e, axis=1)
        g = _silu(x_sel @ w_gate)
        u = x_sel @ w_up
        y = (g * u) @ w_down
        r_sel = _sigmoid((lambda x, i, axis: torch.take_along_dim(x, i, dim=axis))(r, idx, axis=1))
        y = y * r_sel.reshape(B, C, 1)
        b_off = (torch.arange(B) * S).reshape(B, 1)
        flat_idx = (idx + b_off).reshape(B * C)
        zero = (x * 0.0).reshape(B * S, D)
        upd = _scatter_add(zero, flat_idx, y.reshape(B * C, D), axis=0)
        return x + upd.reshape(B, S, D)

    x = A_x
    xn = _layernorm(x, axis=-1)
    s = _A_ref(xn, A_wqkv, A_wo)
    g = _silu(_B_ref(xn, B_w_r, B_w_gate, B_w_up, B_w_down))
    return x + s * g
```

```asm
; @launch grid=(256,1,1) block=(768,1,1) lds=163840
.amdgcn_target "amdgcn-amd-amdhsa--gfx950"
.text
.globl recurrent_scan__mha_block__moe_arch_mod__prompt_kernel
.p2align 8
.type recurrent_scan__mha_block__moe_arch_mod__prompt_kernel,@function
recurrent_scan__mha_block__moe_arch_mod__prompt_kernel:
    s_load_dwordx4 s[4:7], s[0:1], 0
    s_load_dwordx4 s[92:95], s[0:1], 72
    s_load_dwordx2 s[52:53], s[0:1], 32
    s_getpc_b64 s[36:37]
pf_1:
    v_lshlrev_b32 v1, 6, v0
    v_min_u32 v1, code_end-pf_1-4, v1
    global_load_dword v2, v1, s[36:37]
    s_cmp_ge_u32 s2, 256
    s_cbranch_scc1 k1_end
    s_memrealtime s[56:57]
    v_lshrrev_b32 v3, 6, v0
    v_and_b32 v122, 63, v0
    v_readfirstlane_b32 s17, v3
    s_mov_b32 s10, 1572864
    s_mov_b32 s11, 0x20000
    s_mov_b32 s14, 0xc00000
    s_mov_b32 s15, 0x20000
    s_mov_b32 s34, 0x3f803f80
    s_and_b32 s18, s17, 3
    s_and_b32 s25, s2, 7
    s_lshr_b32 s26, s2, 3
    s_lshr_b32 s19, s25, 1
    s_lshl_b32 s19, s19, 3
    s_and_b32 s27, s26, 7
    s_add_u32 s19, s19, s27
    s_and_b32 s20, s25, 1
    s_lshl_b32 s20, s20, 2
    s_lshr_b32 s27, s26, 3
    s_add_u32 s20, s20, s27
    s_and_b32 s21, s19, 3
    s_lshl_b32 s21, s21, 1
    s_cmp_lt_u32 s17, 4
    s_cbranch_scc1 k1_aux
    s_cmp_lt_u32 s17, 8
    s_cbranch_scc1 k1_dma
    s_and_b32 s30, s18, 1
    s_lshr_b32 s31, s18, 1
    s_lshl_b32 s35, s19, 1
    s_add_u32 s35, s35, s30
    s_lshl_b32 s32, s30, 12
    v_lshlrev_b32 v4, 4, v122
    v_and_b32 v8, 31, v122
    v_lshrrev_b32 v9, 5, v122
    v_bfe_u32 v10, v122, 1, 3
    v_xor_b32 v10, v10, v9
    v_lshlrev_b32 v11, 7, v8
    v_add_u32 v11, s32, v11
    v_xor_b32 v13, 0, v10
    v_lshl_add_u32 v112, v13, 4, v11
    v_mov_b32 v116, v112
    v_xor_b32 v13, 2, v10
    v_lshl_add_u32 v113, v13, 4, v11
    v_mov_b32 v117, v113
    v_xor_b32 v13, 4, v10
    v_lshl_add_u32 v114, v13, 4, v11
    v_mov_b32 v118, v114
    v_xor_b32 v13, 6, v10
    v_lshl_add_u32 v115, v13, 4, v11
    v_mov_b32 v119, v115
    v_bfe_u32 v13, v122, 2, 2
    v_lshrrev_b32 v14, 5, v122
    v_lshl_add_u32 v12, v14, 3, v13
    v_mul_u32_u24 v12, 256, v12
    v_and_b32 v14, 16, v122
    v_lshl_add_u32 v12, v14, 1, v12
    v_and_b32 v14, 3, v122
    v_lshl_add_u32 v12, v14, 3, v12
    v_add_u32 v12, 65536, v12
    s_lshl_b32 s27, s31, 1
    s_add_u32 s28, s27, 0
    v_xor_b32 v14, s28, v13
    v_lshl_add_u32 v48, v14, 6, v12
    v_mov_b32 v50, v48
    s_add_u32 s28, s27, 1
    v_xor_b32 v14, s28, v13
    v_lshl_add_u32 v49, v14, 6, v12
    v_mov_b32 v51, v49
    s_lshl_b32 s28, s31, 10
    s_add_u32 s28, s28, 147456
    v_lshl_add_u32 v6, v8, 4, s28
    s_lshl_b32 s28, s30, 7
    s_add_u32 s28, s28, 147456
    v_lshl_add_u32 v7, v8, 2, s28
    v_lshlrev_b32 v11, 9, v9
    v_and_b32 v10, 16, v122
    v_lshlrev_b32 v10, 13, v10
    v_add_u32 v10, v10, v11
    v_and_b32 v12, 15, v122
    v_lshl_add_u32 v10, v12, 4, v10
    v_lshl_add_u32 v9, v9, 4, s28
    v_mov_b32 v15, 163776
    s_mov_b32 s36, -1
    s_mov_b32 s37, 0
    s_and_b32 s27, s20, 3
    s_lshl_b32 s27, s27, 3
    s_lshl_b32 s28, s31, 2
    s_add_u32 s27, s27, s28
    s_lshl_b32 s48, s27, 17
    s_lshl_b32 s28, s35, 11
    s_add_u32 s48, s48, s28
    s_lshr_b32 s28, s20, 2
    s_lshl_b32 s28, s28, 10
    s_add_u32 s48, s48, s28
    s_add_u32 s48, s48, 0x200000
    s_add_u32 s49, s48, 0x20000
    s_add_u32 s50, s48, 0x40000
    s_add_u32 s51, s48, 0x60000
    s_lshl_b32 s44, s27, 9
    s_lshl_b32 s28, s35, 3
    s_add_u32 s44, s44, s28
    s_add_u32 s44, s44, 0xa1c000
    s_lshl_b32 s45, s20, 1
    s_add_u32 s45, s45, s31
    s_lshl_b32 s45, s45, 6
    s_add_u32 s45, s45, s35
    s_lshl_b32 s45, s45, 7
    s_add_u32 s45, s45, 0xa40000
    s_mov_b32 s24, 0
    s_mov_b32 s29, 0
    v_mov_b64 v[64:65], 0
    v_mov_b64 v[66:67], 0
    v_mov_b64 v[68:69], 0
    v_mov_b64 v[70:71], 0
    v_mov_b64 v[72:73], 0
    v_mov_b64 v[74:75], 0
    v_mov_b64 v[76:77], 0
    v_mov_b64 v[78:79], 0
    v_mov_b64 v[80:81], 0
    v_mov_b64 v[82:83], 0
    v_mov_b64 v[84:85], 0
    v_mov_b64 v[86:87], 0
    v_mov_b64 v[88:89], 0
    v_mov_b64 v[90:91], 0
    v_mov_b64 v[92:93], 0
    v_mov_b64 v[94:95], 0
    s_waitcnt lgkmcnt(0)
    s_mov_b64 s[8:9], s[6:7]
    s_mov_b32 s6, 0x200000
    s_mov_b32 s7, 0x20000
    s_mov_b64 s[54:55], s[92:93]
    s_mov_b64 s[12:13], s[94:95]
    s_mov_b32 s52, s44
    s_mov_b32 s53, s45
    s_lshl_b32 s46, s20, 1
    s_add_u32 s46, s46, s31
    s_lshl_b32 s46, s46, 17
    s_lshl_b32 s28, s35, 10
    s_add_u32 s46, s46, s28
    s_add_u32 s47, s46, 0x10000
    v_mov_b32 v140, -1
    v_mov_b32 v141, -1
    v_mov_b32 v142, -1
    v_mov_b32 v143, -1
    s_barrier
    ds_read_b64_tr_b16 v[32:33], v50 offset:0
    ds_read_b64_tr_b16 v[34:35], v50 offset:1024
    ds_read_b128 v[16:19], v116
    ds_read_b64_tr_b16 v[36:37], v51 offset:0
    ds_read_b64_tr_b16 v[38:39], v51 offset:1024
    ds_read_b128 v[20:23], v117
    ds_read_b64_tr_b16 v[40:41], v50 offset:4096
    ds_read_b64_tr_b16 v[42:43], v50 offset:5120
    ds_read_b128 v[24:27], v118
    ds_read_b64_tr_b16 v[44:45], v51 offset:4096
    ds_read_b64_tr_b16 v[46:47], v51 offset:5120
    ds_read_b128 v[28:31], v119
    buffer_store_dwordx4 v[140:143], v4, s[12:15], s46 offen sc1
    buffer_store_dwordx4 v[140:143], v4, s[12:15], s47 offen sc1
    s_cmp_lt_u32 s35, 12
    s_cbranch_scc0 k1_nomark
    buffer_store_dwordx4 v[140:143], v4, s[12:15], s48 offen sc1
    buffer_store_dwordx4 v[140:143], v4, s[12:15], s49 offen sc1
    buffer_store_dwordx4 v[140:143], v4, s[12:15], s50 offen sc1
    buffer_store_dwordx4 v[140:143], v4, s[12:15], s51 offen sc1
k1_nomark:
    s_cmp_ge_u32 s20, 4
    s_cbranch_scc1 k1_loop_V
k1_loop_K:
    s_waitcnt lgkmcnt(9)
    v_mfma_f32_32x32x16_bf16 v[64:79], v[32:35], v[16:19], v[64:79]
    ds_read_b64_tr_b16 v[32:33], v50 offset:8192
    ds_read_b64_tr_b16 v[34:35], v50 offset:9216
    s_add_u32 s24, s24, 1
    s_add_u32 s29, s29, 16384
    s_cmp_eq_u32 s29, 81920
    s_cselect_b32 s29, 0, s29
    v_add_u32 v116, 0x2000, v116
    v_add_u32 v117, 0x2000, v117
    s_waitcnt lgkmcnt(9)
    v_mfma_f32_32x32x16_bf16 v[80:95], v[36:39], v[16:19], v[80:95]
    ds_read_b64_tr_b16 v[36:37], v51 offset:8192
    ds_read_b64_tr_b16 v[38:39], v51 offset:9216
    v_add_u32 v118, 0x2000, v118
    v_add_u32 v119, 0x2000, v119
    s_waitcnt lgkmcnt(8)
    v_mfma_f32_32x32x16_bf16 v[64:79], v[40:43], v[20:23], v[64:79]
    ds_read_b64_tr_b16 v[40:41], v50 offset:12288
    ds_read_b64_tr_b16 v[42:43], v50 offset:13312
    s_waitcnt lgkmcnt(7)
    v_mfma_f32_32x32x16_bf16 v[80:95], v[44:47], v[20:23], v[80:95]
    ds_read_b64_tr_b16 v[44:45], v51 offset:12288
    ds_read_b64_tr_b16 v[46:47], v51 offset:13312
    v_add_u32 v50, s29, v48
    v_add_u32 v51, s29, v49
    s_cmp_eq_u32 s24, 3
    s_cbranch_scc0 k1_nw_2
    s_waitcnt vmcnt(0)
k1_nw_2:
    s_barrier
    s_waitcnt lgkmcnt(6)
    v_mfma_f32_32x32x16_bf16 v[64:79], v[32:35], v[24:27], v[64:79]
    ds_read_b64_tr_b16 v[32:33], v50 offset:0
    ds_read_b64_tr_b16 v[34:35], v50 offset:1024
    ds_read_b128 v[16:19], v116
    s_waitcnt lgkmcnt(7)
    v_mfma_f32_32x32x16_bf16 v[80:95], v[36:39], v[24:27], v[80:95]
    ds_read_b64_tr_b16 v[36:37], v51 offset:0
    ds_read_b64_tr_b16 v[38:39], v51 offset:1024
    ds_read_b128 v[20:23], v117
    s_waitcnt lgkmcnt(8)
    v_mfma_f32_32x32x16_bf16 v[64:79], v[40:43], v[28:31], v[64:79]
    ds_read_b64_tr_b16 v[40:41], v50 offset:4096
    ds_read_b64_tr_b16 v[42:43], v50 offset:5120
    ds_read_b128 v[24:27], v118
    s_waitcnt lgkmcnt(9)
    v_mfma_f32_32x32x16_bf16 v[80:95], v[44:47], v[28:31], v[80:95]
    ds_read_b64_tr_b16 v[44:45], v51 offset:4096
    ds_read_b64_tr_b16 v[46:47], v51 offset:5120
    ds_read_b128 v[28:31], v119
    s_cmp_lt_u32 s24, 7
    s_cbranch_scc1 k1_loop_K
    s_waitcnt lgkmcnt(9)
    v_mfma_f32_32x32x16_bf16 v[64:79], v[32:35], v[16:19], v[64:79]
    ds_read_b64_tr_b16 v[32:33], v50 offset:8192
    ds_read_b64_tr_b16 v[34:35], v50 offset:9216
    s_waitcnt lgkmcnt(9)
    v_mfma_f32_32x32x16_bf16 v[80:95], v[36:39], v[16:19], v[80:95]
    ds_read_b64_tr_b16 v[36:37], v51 offset:8192
    ds_read_b64_tr_b16 v[38:39], v51 offset:9216
    s_waitcnt lgkmcnt(8)
    v_mfma_f32_32x32x16_bf16 v[64:79], v[40:43], v[20:23], v[64:79]
    ds_read_b64_tr_b16 v[40:41], v50 offset:12288
    ds_read_b64_tr_b16 v[42:43], v50 offset:13312
    s_waitcnt lgkmcnt(7)
    v_mfma_f32_32x32x16_bf16 v[80:95], v[44:47], v[20:23], v[80:95]
    ds_read_b64_tr_b16 v[44:45], v51 offset:12288
    ds_read_b64_tr_b16 v[46:47], v51 offset:13312
    s_barrier
    ds_read_b32 v128, v7 offset:3328
    ds_read_b128 v[156:159], v6 offset:0
    ds_read_b128 v[160:163], v6 offset:512
    ds_read_b32 v124, v7 offset:3072
    ds_read_b32 v129, v15
    s_waitcnt lgkmcnt(11)
    v_mfma_f32_32x32x16_bf16 v[64:79], v[32:35], v[24:27], v[64:79]
    s_waitcnt lgkmcnt(9)
    v_mfma_f32_32x32x16_bf16 v[80:95], v[36:39], v[24:27], v[80:95]
    s_waitcnt lgkmcnt(0)
    v_cndmask_b32 v164, 0, v128, s[36:37]
    v_cndmask_b32 v165, 0, v128, s[36:37]
    v_cndmask_b32 v166, 0, v128, s[36:37]
    v_cndmask_b32 v167, 0, v128, s[36:37]
    v_mfma_f32_32x32x16_bf16 v[64:79], v[40:43], v[28:31], v[64:79]
    v_mfma_f32_32x32x16_bf16 v[80:95], v[44:47], v[28:31], v[80:95]
    v_mfma_f32_32x32x16_bf16 v[64:79], v[156:159], v[164:167], v[64:79]
    v_mfma_f32_32x32x16_bf16 v[80:95], v[160:163], v[164:167], v[80:95]
    s_barrier
    s_nop 9
    v_mul_f32 v64, v64, v124
    v_mul_f32 v65, v65, v124
    v_cvt_pk_bf16_f32 v54, v64, v65
    v_mul_f32 v66, v66, v124
    v_mul_f32 v67, v67, v124
    v_cvt_pk_bf16_f32 v55, v66, v67
    v_mul_f32 v68, v68, v124
    v_mul_f32 v69, v69, v124
    v_cvt_pk_bf16_f32 v56, v68, v69
    v_mul_f32 v70, v70, v124
    v_mul_f32 v71, v71, v124
    v_cvt_pk_bf16_f32 v57, v70, v71
    v_min_u32 v54, -2, v54
    v_min_u32 v55, -2, v55
    v_min_u32 v56, -2, v56
    v_min_u32 v57, -2, v57
    buffer_store_dwordx4 v[54:57], v4, s[12:15], s48 offen sc1
    v_mul_f32 v72, v72, v124
    v_mul_f32 v73, v73, v124
    v_cvt_pk_bf16_f32 v58, v72, v73
    v_mul_f32 v74, v74, v124
    v_mul_f32 v75, v75, v124
    v_cvt_pk_bf16_f32 v59, v74, v75
    v_mul_f32 v76, v76, v124
    v_mul_f32 v77, v77, v124
    v_cvt_pk_bf16_f32 v60, v76, v77
    v_mul_f32 v78, v78, v124
    v_mul_f32 v79, v79, v124
    v_cvt_pk_bf16_f32 v61, v78, v79
    v_min_u32 v58, -2, v58
    v_min_u32 v59, -2, v59
    v_min_u32 v60, -2, v60
    v_min_u32 v61, -2, v61
    buffer_store_dwordx4 v[58:61], v4, s[12:15], s49 offen sc1
    s_barrier
    v_mul_f32 v80, v80, v124
    v_mul_f32 v81, v81, v124
    v_cvt_pk_bf16_f32 v132, v80, v81
    v_mul_f32 v82, v82, v124
    v_mul_f32 v83, v83, v124
    v_cvt_pk_bf16_f32 v133, v82, v83
    v_mul_f32 v84, v84, v124
    v_mul_f32 v85, v85, v124
    v_cvt_pk_bf16_f32 v134, v84, v85
    v_mul_f32 v86, v86, v124
    v_mul_f32 v87, v87, v124
    v_cvt_pk_bf16_f32 v135, v86, v87
    v_min_u32 v132, -2, v132
    v_min_u32 v133, -2, v133
    v_min_u32 v134, -2, v134
    v_min_u32 v135, -2, v135
    buffer_store_dwordx4 v[132:135], v4, s[12:15], s50 offen sc1
    v_mul_f32 v88, v88, v124
    v_mul_f32 v89, v89, v124
    v_cvt_pk_bf16_f32 v136, v88, v89
    v_mul_f32 v90, v90, v124
    v_mul_f32 v91, v91, v124
    v_cvt_pk_bf16_f32 v137, v90, v91
    v_mul_f32 v92, v92, v124
    v_mul_f32 v93, v93, v124
    v_cvt_pk_bf16_f32 v138, v92, v93
    v_mul_f32 v94, v94, v124
    v_mul_f32 v95, v95, v124
    v_cvt_pk_bf16_f32 v139, v94, v95
    v_min_u32 v136, -2, v136
    v_min_u32 v137, -2, v137
    v_min_u32 v138, -2, v138
    v_min_u32 v139, -2, v139
    buffer_store_dwordx4 v[136:139], v4, s[12:15], s51 offen sc1
    s_barrier
    v_mul_f32 v140, v64, v64
    v_mul_f32 v141, v72, v72
    v_mul_f32 v142, v80, v80
    v_mul_f32 v143, v88, v88
    v_fmac_f32 v140, v65, v65
    v_fmac_f32 v141, v73, v73
    v_fmac_f32 v142, v81, v81
    v_fmac_f32 v143, v89, v89
    v_fmac_f32 v140, v66, v66
    v_fmac_f32 v141, v74, v74
    v_fmac_f32 v142, v82, v82
    v_fmac_f32 v143, v90, v90
    v_fmac_f32 v140, v67, v67
    v_fmac_f32 v141, v75, v75
    v_fmac_f32 v142, v83, v83
    v_fmac_f32 v143, v91, v91
    v_fmac_f32 v140, v68, v68
    v_fmac_f32 v141, v76, v76
    v_fmac_f32 v142, v84, v84
    v_fmac_f32 v143, v92, v92
    v_fmac_f32 v140, v69, v69
    v_fmac_f32 v141, v77, v77
    v_fmac_f32 v142, v85, v85
    v_fmac_f32 v143, v93, v93
    v_fmac_f32 v140, v70, v70
    v_fmac_f32 v141, v78, v78
    v_fmac_f32 v142, v86, v86
    v_fmac_f32 v143, v94, v94
    v_fmac_f32 v140, v71, v71
    v_fmac_f32 v141, v79, v79
    v_fmac_f32 v142, v87, v87
    v_fmac_f32 v143, v95, v95
    v_permlane32_swap_b32 v140, v141
    s_nop 0
    v_permlane32_swap_b32 v142, v143
    v_add_f32 v140, v140, v141
    v_add_f32 v142, v142, v143
    s_nop 0
    v_max_f32_dpp v140, v140, v140 quad_perm:[1,0,3,2] row_mask:0xf bank_mask:0xf
    v_max_f32_dpp v142, v142, v142 quad_perm:[1,0,3,2] row_mask:0xf bank_mask:0xf
    s_nop 0
    v_max_f32_dpp v140, v140, v140 quad_perm:[2,3,0,1] row_mask:0xf bank_mask:0xf
    v_max_f32_dpp v142, v142, v142 quad_perm:[2,3,0,1] row_mask:0xf bank_mask:0xf
    s_nop 0
    v_max_f32_dpp v140, v140, v140 row_half_mirror row_mask:0xf bank_mask:0xf
    v_max_f32_dpp v142, v142, v142 row_half_mirror row_mask:0xf bank_mask:0xf
    s_nop 0
    v_max_f32_dpp v140, v140, v140 row_mirror row_mask:0xf bank_mask:0xf
    v_max_f32_dpp v142, v142, v142 row_mirror row_mask:0xf bank_mask:0xf
    s_nop 0
    v_max_f32_dpp v140, v140, v140 row_bcast:15 row_mask:0xa bank_mask:0xf
    v_max_f32_dpp v142, v142, v142 row_bcast:15 row_mask:0xa bank_mask:0xf
    v_mov_b32 v141, v129
    v_mov_b32 v143, v129
    s_barrier
    s_mov_b32 exec_lo, 0x80000000
    s_mov_b32 exec_hi, 0x80000000
    buffer_store_dwordx2 v[140:141], v11, s[12:15], s52 offen offset:0 sc1
    buffer_store_dwordx2 v[142:143], v11, s[12:15], s52 offen offset:1024 sc1
    s_mov_b64 exec, -1
    s_mov_b32 s95, 2
    s_mov_b32 s96, s53
    s_mov_b64 exec, -1
    s_branch k2_entry
k1_loop_V:
    s_waitcnt lgkmcnt(9)
    v_mfma_f32_32x32x16_bf16 v[64:79], v[16:19], v[32:35], v[64:79]
    ds_read_b64_tr_b16 v[32:33], v50 offset:8192
    ds_read_b64_tr_b16 v[34:35], v50 offset:9216
    s_add_u32 s24, s24, 1
    s_add_u32 s29, s29, 16384
    s_cmp_eq_u32 s29, 81920
    s_cselect_b32 s29, 0, s29
    v_add_u32 v116, 0x2000, v116
    v_add_u32 v117, 0x2000, v117
    s_waitcnt lgkmcnt(9)
    v_mfma_f32_32x32x16_bf16 v[80:95], v[16:19], v[36:39], v[80:95]
    ds_read_b64_tr_b16 v[36:37], v51 offset:8192
    ds_read_b64_tr_b16 v[38:39], v51 offset:9216
    v_add_u32 v118, 0x2000, v118
    v_add_u32 v119, 0x2000, v119
    s_waitcnt lgkmcnt(8)
    v_mfma_f32_32x32x16_bf16 v[64:79], v[20:23], v[40:43], v[64:79]
    ds_read_b64_tr_b16 v[40:41], v50 offset:12288
    ds_read_b64_tr_b16 v[42:43], v50 offset:13312
    s_waitcnt lgkmcnt(7)
    v_mfma_f32_32x32x16_bf16 v[80:95], v[20:23], v[44:47], v[80:95]
    ds_read_b64_tr_b16 v[44:45], v51 offset:12288
    ds_read_b64_tr_b16 v[46:47], v51 offset:13312
    v_add_u32 v50, s29, v48
    v_add_u32 v51, s29, v49
    s_cmp_eq_u32 s24, 3
    s_cbranch_scc0 k1_nw_3
    s_waitcnt vmcnt(0)
k1_nw_3:
    s_barrier
    s_waitcnt lgkmcnt(6)
    v_mfma_f32_32x32x16_bf16 v[64:79], v[24:27], v[32:35], v[64:79]
    ds_read_b64_tr_b16 v[32:33], v50 offset:0
    ds_read_b64_tr_b16 v[34:35], v50 offset:1024
    ds_read_b128 v[16:19], v116
    s_waitcnt lgkmcnt(7)
    v_mfma_f32_32x32x16_bf16 v[80:95], v[24:27], v[36:39], v[80:95]
    ds_read_b64_tr_b16 v[36:37], v51 offset:0
    ds_read_b64_tr_b16 v[38:39], v51 offset:1024
    ds_read_b128 v[20:23], v117
    s_waitcnt lgkmcnt(8)
    v_mfma_f32_32x32x16_bf16 v[64:79], v[28:31], v[40:43], v[64:79]
    ds_read_b64_tr_b16 v[40:41], v50 offset:4096
    ds_read_b64_tr_b16 v[42:43], v50 offset:5120
    ds_read_b128 v[24:27], v118
    s_waitcnt lgkmcnt(9)
    v_mfma_f32_32x32x16_bf16 v[80:95], v[28:31], v[44:47], v[80:95]
    ds_read_b64_tr_b16 v[44:45], v51 offset:4096
    ds_read_b64_tr_b16 v[46:47], v51 offset:5120
    ds_read_b128 v[28:31], v119
    s_cmp_lt_u32 s24, 7
    s_cbranch_scc1 k1_loop_V
    s_waitcnt lgkmcnt(9)
    v_mfma_f32_32x32x16_bf16 v[64:79], v[16:19], v[32:35], v[64:79]
    ds_read_b64_tr_b16 v[32:33], v50 offset:8192
    ds_read_b64_tr_b16 v[34:35], v50 offset:9216
    s_waitcnt lgkmcnt(9)
    v_mfma_f32_32x32x16_bf16 v[80:95], v[16:19], v[36:39], v[80:95]
    ds_read_b64_tr_b16 v[36:37], v51 offset:8192
    ds_read_b64_tr_b16 v[38:39], v51 offset:9216
    s_waitcnt lgkmcnt(8)
    v_mfma_f32_32x32x16_bf16 v[64:79], v[20:23], v[40:43], v[64:79]
    ds_read_b64_tr_b16 v[40:41], v50 offset:12288
    ds_read_b64_tr_b16 v[42:43], v50 offset:13312
    s_waitcnt lgkmcnt(7)
    v_mfma_f32_32x32x16_bf16 v[80:95], v[20:23], v[44:47], v[80:95]
    ds_read_b64_tr_b16 v[44:45], v51 offset:12288
    ds_read_b64_tr_b16 v[46:47], v51 offset:13312
    s_barrier
    ds_read_b32 v128, v7 offset:3328
    ds_read_b128 v[156:159], v6 offset:0
    ds_read_b128 v[160:163], v6 offset:512
    ds_read_b32 v124, v7 offset:3072
    ds_read_b32 v129, v15
    ds_read_b128 v[140:143], v9 offset:3072
    ds_read_b128 v[144:147], v9 offset:3104
    ds_read_b128 v[148:151], v9 offset:3136
    ds_read_b128 v[152:155], v9 offset:3168
    s_waitcnt lgkmcnt(15)
    v_mfma_f32_32x32x16_bf16 v[64:79], v[24:27], v[32:35], v[64:79]
    s_waitcnt lgkmcnt(13)
    v_mfma_f32_32x32x16_bf16 v[80:95], v[24:27], v[36:39], v[80:95]
    s_waitcnt lgkmcnt(0)
    v_cndmask_b32 v164, 0, v128, s[36:37]
    v_cndmask_b32 v165, 0, v128, s[36:37]
    v_cndmask_b32 v166, 0, v128, s[36:37]
    v_cndmask_b32 v167, 0, v128, s[36:37]
    v_mfma_f32_32x32x16_bf16 v[64:79], v[28:31], v[40:43], v[64:79]
    v_mfma_f32_32x32x16_bf16 v[80:95], v[28:31], v[44:47], v[80:95]
    v_mfma_f32_32x32x16_bf16 v[64:79], v[164:167], v[156:159], v[64:79]
    v_mfma_f32_32x32x16_bf16 v[80:95], v[164:167], v[160:163], v[80:95]
    s_barrier
    s_nop 9
    v_mul_f32 v64, v64, v140
    v_mul_f32 v65, v65, v141
    v_cvt_pk_bf16_f32 v54, v64, v65
    v_mul_f32 v66, v66, v142
    v_mul_f32 v67, v67, v143
    v_cvt_pk_bf16_f32 v55, v66, v67
    v_mul_f32 v68, v68, v144
    v_mul_f32 v69, v69, v145
    v_cvt_pk_bf16_f32 v56, v68, v69
    v_mul_f32 v70, v70, v146
    v_mul_f32 v71, v71, v147
    v_cvt_pk_bf16_f32 v57, v70, v71
    v_min_u32 v54, -2, v54
    v_min_u32 v55, -2, v55
    v_min_u32 v56, -2, v56
    v_min_u32 v57, -2, v57
    buffer_store_dwordx4 v[54:57], v10, s[12:15], s48 offen offset:0 sc1
    v_mul_f32 v72, v72, v148
    v_mul_f32 v73, v73, v149
    v_cvt_pk_bf16_f32 v58, v72, v73
    v_mul_f32 v74, v74, v150
    v_mul_f32 v75, v75, v151
    v_cvt_pk_bf16_f32 v59, v74, v75
    v_mul_f32 v76, v76, v152
    v_mul_f32 v77, v77, v153
    v_cvt_pk_bf16_f32 v60, v76, v77
    v_mul_f32 v78, v78, v154
    v_mul_f32 v79, v79, v155
    v_cvt_pk_bf16_f32 v61, v78, v79
    v_min_u32 v58, -2, v58
    v_min_u32 v59, -2, v59
    v_min_u32 v60, -2, v60
    v_min_u32 v61, -2, v61
    buffer_store_dwordx4 v[58:61], v10, s[12:15], s48 offen offset:256 sc1
    s_barrier
    v_mul_f32 v80, v80, v140
    v_mul_f32 v81, v81, v141
    v_cvt_pk_bf16_f32 v132, v80, v81
    v_mul_f32 v82, v82, v142
    v_mul_f32 v83, v83, v143
    v_cvt_pk_bf16_f32 v133, v82, v83
    v_mul_f32 v84, v84, v144
    v_mul_f32 v85, v85, v145
    v_cvt_pk_bf16_f32 v134, v84, v85
    v_mul_f32 v86, v86, v146
    v_mul_f32 v87, v87, v147
    v_cvt_pk_bf16_f32 v135, v86, v87
    v_min_u32 v132, -2, v132
    v_min_u32 v133, -2, v133
    v_min_u32 v134, -2, v134
    v_min_u32 v135, -2, v135
    buffer_store_dwordx4 v[132:135], v10, s[12:15], s50 offen offset:0 sc1
    v_mul_f32 v88, v88, v148
    v_mul_f32 v89, v89, v149
    v_cvt_pk_bf16_f32 v136, v88, v89
    v_mul_f32 v90, v90, v150
    v_mul_f32 v91, v91, v151
    v_cvt_pk_bf16_f32 v137, v90, v91
    v_mul_f32 v92, v92, v152
    v_mul_f32 v93, v93, v153
    v_cvt_pk_bf16_f32 v138, v92, v93
    v_mul_f32 v94, v94, v154
    v_mul_f32 v95, v95, v155
    v_cvt_pk_bf16_f32 v139, v94, v95
    v_min_u32 v136, -2, v136
    v_min_u32 v137, -2, v137
    v_min_u32 v138, -2, v138
    v_min_u32 v139, -2, v139
    buffer_store_dwordx4 v[136:139], v10, s[12:15], s50 offen offset:256 sc1
    s_barrier
    s_barrier
    s_mov_b32 s95, 0
    s_mov_b32 s96, s53
    s_mov_b64 exec, -1
    s_branch k2_entry
k1_dma:
    v_lshrrev_b32 v5, 3, v122
    v_lshrrev_b32 v6, 4, v122
    v_and_b32 v7, 7, v122
    v_xor_b32 v8, v7, v6
    v_lshlrev_b32 v8, 4, v8
    v_lshl_add_u32 v96, v5, 10, v8
    v_xor_b32 v97, 64, v96
    s_movk_i32 s27, 3072
    v_and_b32 v8, 15, v122
    v_lshlrev_b32 v9, 2, v6
    v_xor_b32 v8, v8, v9
    v_lshlrev_b32 v8, 4, v8
    v_mad_u32_u24 v98, v6, s27, v8
    s_lshl_b32 s22, s19, 16
    s_lshl_b32 s27, s18, 14
    s_add_u32 s22, s22, s27
    s_mul_i32 s23, s18, 49152
    s_lshl_b32 s27, s20, 8
    s_add_u32 s23, s23, s27
    s_add_u32 s23, s23, 1024
    s_lshl_b32 s32, s18, 11
    s_lshl_b32 s33, s18, 12
    s_add_u32 s33, s33, 65536
    s_waitcnt lgkmcnt(0)
    s_mov_b64 s[8:9], s[6:7]
    s_mov_b32 s6, 0x200000
    s_mov_b32 s7, 0x20000
    s_mov_b64 s[54:55], s[92:93]
    s_mov_b64 s[12:13], s[94:95]
    s_xor_b32 s39, s21, 0
    s_mul_i32 s40, s39, 196608
    s_lshl_b32 s39, s39, 7
    s_add_u32 s39, s39, s22
    s_add_u32 s40, s40, s23
    s_add_u32 m0, s32, 0
    s_add_u32 s30, s39, 0
    buffer_load_dwordx4 v96, s[4:7], s30 offen lds
    s_add_u32 m0, s32, 1024
    s_add_u32 s30, s39, 8192
    buffer_load_dwordx4 v97, s[4:7], s30 offen lds
    s_add_u32 m0, s33, 0
    s_add_u32 s30, s40, 0
    buffer_load_dwordx4 v98, s[8:11], s30 offen lds
    s_add_u32 m0, s33, 1024
    s_add_u32 s30, s40, 12288
    buffer_load_dwordx4 v98, s[8:11], s30 offen lds
    s_add_u32 m0, s33, 2048
    s_add_u32 s30, s40, 24576
    buffer_load_dwordx4 v98, s[8:11], s30 offen lds
    s_add_u32 m0, s33, 3072
    s_add_u32 s30, s40, 36864
    buffer_load_dwordx4 v98, s[8:11], s30 offen lds
    s_xor_b32 s39, s21, 1
    s_mul_i32 s40, s39, 196608
    s_lshl_b32 s39, s39, 7
    s_add_u32 s39, s39, s22
    s_add_u32 s40, s40, s23
    s_add_u32 m0, s32, 8192
    s_add_u32 s30, s39, 0
    buffer_load_dwordx4 v96, s[4:7], s30 offen lds
    s_add_u32 m0, s32, 9216
    s_add_u32 s30, s39, 8192
    buffer_load_dwordx4 v97, s[4:7], s30 offen lds
    s_add_u32 m0, s33, 16384
    s_add_u32 s30, s40, 0
    buffer_load_dwordx4 v98, s[8:11], s30 offen lds
    s_add_u32 m0, s33, 17408
    s_add_u32 s30, s40, 12288
    buffer_load_dwordx4 v98, s[8:11], s30 offen lds
    s_add_u32 m0, s33, 18432
    s_add_u32 s30, s40, 24576
    buffer_load_dwordx4 v98, s[8:11], s30 offen lds
    s_add_u32 m0, s33, 19456
    s_add_u32 s30, s40, 36864
    buffer_load_dwordx4 v98, s[8:11], s30 offen lds
    s_movk_i32 s27, 3072
    v_and_b32 v9, 1, v6
    v_lshlrev_b32 v9, 2, v9
    v_xor_b32 v8, v7, v9
    v_lshlrev_b32 v8, 4, v8
    v_mad_u32_u24 v99, v5, s27, v8
    s_mul_i32 s28, s18, 98304
    s_lshl_b32 s27, s20, 7
    s_add_u32 s28, s28, s27
    s_and_b32 s38, s21, 6
    s_and_b32 s27, s21, 1
    s_mul_i32 s27, s27, 196608
    s_sub_u32 s30, 0, s27
    s_cmp_lt_u32 s18, 2
    s_cselect_b32 s27, s27, s30
    s_add_u32 s28, s28, s27
    s_and_b32 s36, s18, 1
    s_lshr_b32 s31, s18, 1
    s_lshl_b32 s35, s19, 1
    s_add_u32 s35, s35, s36
    s_mov_b32 s37, s32
    s_lshl_b32 s32, s36, 12
    v_and_b32 v8, 31, v122
    v_lshrrev_b32 v9, 5, v122
    v_bfe_u32 v10, v122, 1, 3
    v_xor_b32 v10, v10, v9
    v_lshlrev_b32 v11, 7, v8
    v_add_u32 v11, s32, v11
    v_xor_b32 v13, 0, v10
    v_lshl_add_u32 v112, v13, 4, v11
    v_mov_b32 v116, v112
    v_xor_b32 v13, 2, v10
    v_lshl_add_u32 v113, v13, 4, v11
    v_mov_b32 v117, v113
    v_xor_b32 v13, 4, v10
    v_lshl_add_u32 v114, v13, 4, v11
    v_mov_b32 v118, v114
    v_xor_b32 v13, 6, v10
    v_lshl_add_u32 v115, v13, 4, v11
    v_mov_b32 v119, v115
    s_mov_b32 s32, s37
    v_bfe_u32 v13, v122, 2, 2
    v_lshrrev_b32 v14, 5, v122
    v_lshl_add_u32 v12, v14, 3, v13
    v_mul_u32_u24 v12, 128, v12
    v_and_b32 v14, 16, v122
    v_lshl_add_u32 v12, v14, 1, v12
    v_and_b32 v14, 3, v122
    v_lshl_add_u32 v12, v14, 3, v12
    v_lshrrev_b32 v13, 1, v13
    v_xor_b32 v13, s31, v13
    v_lshl_add_u32 v12, v13, 6, v12
    v_add_u32 v52, 65536, v12
    v_add_u32 v53, 131072, v12
    s_lshl_b32 s45, s31, 9
    s_add_u32 s45, s45, 147456
    v_lshl_add_u32 v6, v8, 4, s45
    s_lshl_b32 s45, s36, 7
    s_add_u32 s45, s45, 147456
    v_lshl_add_u32 v7, v8, 2, s45
    v_lshlrev_b32 v4, 4, v122
    s_lshl_b32 s45, s20, 1
    s_add_u32 s45, s45, s31
    s_lshl_b32 s46, s45, 17
    s_lshl_b32 s47, s35, 10
    s_add_u32 s46, s46, s47
    s_add_u32 s47, s46, 0x10000
    s_lshl_b32 s45, s45, 6
    s_add_u32 s45, s45, s35
    s_lshl_b32 s45, s45, 7
    s_add_u32 s96, s45, 0xa80000
    s_mov_b32 s36, -1
    s_mov_b32 s37, 0
    s_waitcnt vmcnt(6)
    s_barrier
    s_xor_b32 s39, s21, 2
    s_mul_i32 s40, s39, 196608
    s_lshl_b32 s39, s39, 7
    s_add_u32 s39, s39, s22
    s_add_u32 s40, s40, s23
    s_add_u32 m0, s32, 16384
    s_add_u32 s30, s39, 0
    buffer_load_dwordx4 v96, s[4:7], s30 offen lds
    s_add_u32 m0, s32, 17408
    s_add_u32 s30, s39, 8192
    buffer_load_dwordx4 v97, s[4:7], s30 offen lds
    s_add_u32 m0, s33, 32768
    s_add_u32 s30, s40, 0
    buffer_load_dwordx4 v98, s[8:11], s30 offen lds
    s_add_u32 m0, s33, 33792
    s_add_u32 s30, s40, 12288
    buffer_load_dwordx4 v98, s[8:11], s30 offen lds
    s_add_u32 m0, s33, 34816
    s_add_u32 s30, s40, 24576
    buffer_load_dwordx4 v98, s[8:11], s30 offen lds
    s_add_u32 m0, s33, 35840
    s_add_u32 s30, s40, 36864
    buffer_load_dwordx4 v98, s[8:11], s30 offen lds
    s_xor_b32 s39, s21, 3
    s_mul_i32 s40, s39, 196608
    s_lshl_b32 s39, s39, 7
    s_add_u32 s39, s39, s22
    s_add_u32 s40, s40, s23
    s_add_u32 m0, s32, 24576
    s_add_u32 s30, s39, 0
    buffer_load_dwordx4 v96, s[4:7], s30 offen lds
    s_add_u32 m0, s32, 25600
    s_add_u32 s30, s39, 8192
    buffer_load_dwordx4 v97, s[4:7], s30 offen lds
    s_add_u32 m0, s33, 49152
    s_add_u32 s30, s40, 0
    buffer_load_dwordx4 v98, s[8:11], s30 offen lds
    s_add_u32 m0, s33, 50176
    s_add_u32 s30, s40, 12288
    buffer_load_dwordx4 v98, s[8:11], s30 offen lds
    s_add_u32 m0, s33, 51200
    s_add_u32 s30, s40, 24576
    buffer_load_dwordx4 v98, s[8:11], s30 offen lds
    s_add_u32 m0, s33, 52224
    s_add_u32 s30, s40, 36864
    buffer_load_dwordx4 v98, s[8:11], s30 offen lds
    s_waitcnt vmcnt(12)
    s_barrier
    s_xor_b32 s39, s21, 4
    s_mul_i32 s40, s39, 196608
    s_lshl_b32 s39, s39, 7
    s_add_u32 s39, s39, s22
    s_add_u32 s40, s40, s23
    s_add_u32 m0, s32, 32768
    s_add_u32 s30, s39, 0
    buffer_load_dwordx4 v96, s[4:7], s30 offen lds
    s_add_u32 m0, s32, 33792
    s_add_u32 s30, s39, 8192
    buffer_load_dwordx4 v97, s[4:7], s30 offen lds
    s_add_u32 m0, s33, 65536
    s_add_u32 s30, s40, 0
    buffer_load_dwordx4 v98, s[8:11], s30 offen lds
    s_add_u32 m0, s33, 66560
    s_add_u32 s30, s40, 12288
    buffer_load_dwordx4 v98, s[8:11], s30 offen lds
    s_add_u32 m0, s33, 67584
    s_add_u32 s30, s40, 24576
    buffer_load_dwordx4 v98, s[8:11], s30 offen lds
    s_add_u32 m0, s33, 68608
    s_add_u32 s30, s40, 36864
    buffer_load_dwordx4 v98, s[8:11], s30 offen lds
    s_waitcnt vmcnt(12)
    s_barrier
    s_xor_b32 s39, s21, 5
    s_mul_i32 s40, s39, 196608
    s_lshl_b32 s39, s39, 7
    s_add_u32 s39, s39, s22
    s_add_u32 s40, s40, s23
    s_add_u32 m0, s32, 40960
    s_add_u32 s30, s39, 0
    buffer_load_dwordx4 v96, s[4:7], s30 offen lds
    s_add_u32 m0, s32, 41984
    s_add_u32 s30, s39, 8192
    buffer_load_dwordx4 v97, s[4:7], s30 offen lds
    s_add_u32 m0, s33, 0
    s_add_u32 s30, s40, 0
    buffer_load_dwordx4 v98, s[8:11], s30 offen lds
    s_add_u32 m0, s33, 1024
    s_add_u32 s30, s40, 12288
    buffer_load_dwordx4 v98, s[8:11], s30 offen lds
    s_add_u32 m0, s33, 2048
    s_add_u32 s30, s40, 24576
    buffer_load_dwordx4 v98, s[8:11], s30 offen lds
    s_add_u32 m0, s33, 3072
    s_add_u32 s30, s40, 36864
    buffer_load_dwordx4 v98, s[8:11], s30 offen lds
    s_waitcnt vmcnt(12)
    s_barrier
    s_xor_b32 s39, s21, 6
    s_mul_i32 s40, s39, 196608
    s_lshl_b32 s39, s39, 7
    s_add_u32 s39, s39, s22
    s_add_u32 s40, s40, s23
    s_add_u32 m0, s32, 49152
    s_add_u32 s30, s39, 0
    buffer_load_dwordx4 v96, s[4:7], s30 offen lds
    s_add_u32 m0, s32, 50176
    s_add_u32 s30, s39, 8192
    buffer_load_dwordx4 v97, s[4:7], s30 offen lds
    s_add_u32 m0, s33, 16384
    s_add_u32 s30, s40, 0
    buffer_load_dwordx4 v98, s[8:11], s30 offen lds
    s_add_u32 m0, s33, 17408
    s_add_u32 s30, s40, 12288
    buffer_load_dwordx4 v98, s[8:11], s30 offen lds
    s_add_u32 m0, s33, 18432
    s_add_u32 s30, s40, 24576
    buffer_load_dwordx4 v98, s[8:11], s30 offen lds
    s_add_u32 m0, s33, 19456
    s_add_u32 s30, s40, 36864
    buffer_load_dwordx4 v98, s[8:11], s30 offen lds
    s_waitcnt vmcnt(12)
    s_barrier
    s_xor_b32 s39, s21, 7
    s_mul_i32 s40, s39, 196608
    s_lshl_b32 s39, s39, 7
    s_add_u32 s39, s39, s22
    s_add_u32 s40, s40, s23
    s_add_u32 m0, s32, 57344
    s_add_u32 s30, s39, 0
    buffer_load_dwordx4 v96, s[4:7], s30 offen lds
    s_add_u32 m0, s32, 58368
    s_add_u32 s30, s39, 8192
    buffer_load_dwordx4 v97, s[4:7], s30 offen lds
    s_add_u32 m0, s33, 32768
    s_add_u32 s30, s40, 0
    buffer_load_dwordx4 v98, s[8:11], s30 offen lds
    s_add_u32 m0, s33, 33792
    s_add_u32 s30, s40, 12288
    buffer_load_dwordx4 v98, s[8:11], s30 offen lds
    s_add_u32 m0, s33, 34816
    s_add_u32 s30, s40, 24576
    buffer_load_dwordx4 v98, s[8:11], s30 offen lds
    s_add_u32 m0, s33, 35840
    s_add_u32 s30, s40, 36864
    buffer_load_dwordx4 v98, s[8:11], s30 offen lds
    s_waitcnt vmcnt(12)
    s_barrier
    s_xor_b32 s39, s38, 0
    s_mul_i32 s40, s39, 196608
    s_add_u32 s40, s40, s28
    s_add_u32 m0, s33, 49152
    s_add_u32 s30, s40, 0
    buffer_load_dwordx4 v99, s[8:11], s30 offen lds
    s_add_u32 m0, s33, 50176
    s_add_u32 s30, s40, 24576
    buffer_load_dwordx4 v99, s[8:11], s30 offen lds
    s_add_u32 m0, s33, 51200
    s_add_u32 s30, s40, 49152
    buffer_load_dwordx4 v99, s[8:11], s30 offen lds
    s_add_u32 m0, s33, 52224
    s_add_u32 s30, s40, 73728
    buffer_load_dwordx4 v99, s[8:11], s30 offen lds
    s_waitcnt vmcnt(10)
    s_barrier
    s_xor_b32 s39, s38, 2
    s_mul_i32 s40, s39, 196608
    s_add_u32 s40, s40, s28
    s_add_u32 m0, s33, 65536
    s_add_u32 s30, s40, 0
    buffer_load_dwordx4 v99, s[8:11], s30 offen lds
    s_add_u32 m0, s33, 66560
    s_add_u32 s30, s40, 24576
    buffer_load_dwordx4 v99, s[8:11], s30 offen lds
    s_add_u32 m0, s33, 67584
    s_add_u32 s30, s40, 49152
    buffer_load_dwordx4 v99, s[8:11], s30 offen lds
    s_add_u32 m0, s33, 68608
    s_add_u32 s30, s40, 73728
    buffer_load_dwordx4 v99, s[8:11], s30 offen lds
    s_waitcnt vmcnt(8)
    s_barrier
    s_xor_b32 s39, s38, 4
    s_mul_i32 s40, s39, 196608
    s_add_u32 s40, s40, s28
    s_add_u32 m0, s33, 0
    s_add_u32 s30, s40, 0
    buffer_load_dwordx4 v99, s[8:11], s30 offen lds
    s_add_u32 m0, s33, 1024
    s_add_u32 s30, s40, 24576
    buffer_load_dwordx4 v99, s[8:11], s30 offen lds
    s_add_u32 m0, s33, 2048
    s_add_u32 s30, s40, 49152
    buffer_load_dwordx4 v99, s[8:11], s30 offen lds
    s_add_u32 m0, s33, 3072
    s_add_u32 s30, s40, 73728
    buffer_load_dwordx4 v99, s[8:11], s30 offen lds
    s_waitcnt vmcnt(8)
    s_barrier
    s_xor_b32 s39, s38, 6
    s_mul_i32 s40, s39, 196608
    s_add_u32 s40, s40, s28
    s_add_u32 m0, s33, 16384
    s_add_u32 s30, s40, 0
    buffer_load_dwordx4 v99, s[8:11], s30 offen lds
    s_add_u32 m0, s33, 17408
    s_add_u32 s30, s40, 24576
    buffer_load_dwordx4 v99, s[8:11], s30 offen lds
    s_add_u32 m0, s33, 18432
    s_add_u32 s30, s40, 49152
    buffer_load_dwordx4 v99, s[8:11], s30 offen lds
    s_add_u32 m0, s33, 19456
    s_add_u32 s30, s40, 73728
    buffer_load_dwordx4 v99, s[8:11], s30 offen lds
    ds_read_b32 v128, v7 offset:3328
    ds_read_b32 v124, v7 offset:3072
    ds_read_b128 v[16:19], v112 offset:0
    ds_read_b64_tr_b16 v[32:33], v52 offset:49152
    ds_read_b64_tr_b16 v[34:35], v52 offset:49664
    ds_read_b128 v[20:23], v113 offset:0
    ds_read_b64_tr_b16 v[36:37], v52 offset:51200
    ds_read_b64_tr_b16 v[38:39], v52 offset:51712
    ds_read_b128 v[24:27], v114 offset:0
    ds_read_b64_tr_b16 v[40:41], v52 offset:53248
    ds_read_b64_tr_b16 v[42:43], v52 offset:53760
    ds_read_b128 v[28:31], v115 offset:0
    ds_read_b64_tr_b16 v[44:45], v52 offset:55296
    ds_read_b64_tr_b16 v[46:47], v52 offset:55808
    s_waitcnt lgkmcnt(9)
    v_mfma_f32_32x32x16_bf16 v[64:79], v[32:35], v[16:19], 0
    ds_read_b128 v[16:19], v112 offset:8192
    ds_read_b64_tr_b16 v[32:33], v52 offset:57344
    ds_read_b64_tr_b16 v[34:35], v52 offset:57856
    s_waitcnt lgkmcnt(9)
    v_mfma_f32_32x32x16_bf16 v[64:79], v[36:39], v[20:23], v[64:79]
    ds_read_b128 v[20:23], v113 offset:8192
    ds_read_b64_tr_b16 v[36:37], v52 offset:59392
    ds_read_b64_tr_b16 v[38:39], v52 offset:59904
    v_cndmask_b32 v164, 0, v128, s[36:37]
    v_cndmask_b32 v165, 0, v128, s[36:37]
    v_cndmask_b32 v166, 0, v128, s[36:37]
    v_cndmask_b32 v167, 0, v128, s[36:37]
    v_mul_f32 v124, 0x3eb8aa3b, v124
    s_waitcnt lgkmcnt(9)
    v_mfma_f32_32x32x16_bf16 v[64:79], v[40:43], v[24:27], v[64:79]
    ds_read_b128 v[24:27], v114 offset:8192
    ds_read_b64_tr_b16 v[40:41], v52 offset:61440
    ds_read_b64_tr_b16 v[42:43], v52 offset:61952
    s_waitcnt lgkmcnt(9)
    v_mfma_f32_32x32x16_bf16 v[64:79], v[44:47], v[28:31], v[64:79]
    ds_read_b128 v[28:31], v115 offset:8192
    ds_read_b64_tr_b16 v[44:45], v52 offset:63488
    ds_read_b64_tr_b16 v[46:47], v52 offset:64000
    s_waitcnt lgkmcnt(9)
    v_mfma_f32_32x32x16_bf16 v[64:79], v[32:35], v[16:19], v[64:79]
    s_waitcnt vmcnt(8)
    s_barrier
    ds_read_b128 v[16:19], v112 offset:16384
    ds_read_b64_tr_b16 v[32:33], v53 offset:0
    ds_read_b64_tr_b16 v[34:35], v53 offset:512
    s_waitcnt lgkmcnt(9)
    v_mfma_f32_32x32x16_bf16 v[64:79], v[36:39], v[20:23], v[64:79]
    ds_read_b128 v[20:23], v113 offset:16384
    ds_read_b64_tr_b16 v[36:37], v53 offset:2048
    ds_read_b64_tr_b16 v[38:39], v53 offset:2560
    s_waitcnt lgkmcnt(9)
    v_mfma_f32_32x32x16_bf16 v[64:79], v[40:43], v[24:27], v[64:79]
    ds_read_b128 v[24:27], v114 offset:16384
    ds_read_b64_tr_b16 v[40:41], v53 offset:4096
    ds_read_b64_tr_b16 v[42:43], v53 offset:4608
    s_waitcnt lgkmcnt(9)
    v_mfma_f32_32x32x16_bf16 v[64:79], v[44:47], v[28:31], v[64:79]
    ds_read_b128 v[28:31], v115 offset:16384
    ds_read_b64_tr_b16 v[44:45], v53 offset:6144
    ds_read_b64_tr_b16 v[46:47], v53 offset:6656
    s_waitcnt lgkmcnt(9)
    v_mfma_f32_32x32x16_bf16 v[64:79], v[32:35], v[16:19], v[64:79]
    ds_read_b128 v[16:19], v112 offset:24576
    ds_read_b64_tr_b16 v[32:33], v53 offset:8192
    ds_read_b64_tr_b16 v[34:35], v53 offset:8704
    s_waitcnt lgkmcnt(9)
    v_mfma_f32_32x32x16_bf16 v[64:79], v[36:39], v[20:23], v[64:79]
    ds_read_b128 v[20:23], v113 offset:24576
    ds_read_b64_tr_b16 v[36:37], v53 offset:10240
    ds_read_b64_tr_b16 v[38:39], v53 offset:10752
    s_waitcnt lgkmcnt(9)
    v_mfma_f32_32x32x16_bf16 v[64:79], v[40:43], v[24:27], v[64:79]
    ds_read_b128 v[24:27], v114 offset:24576
    ds_read_b64_tr_b16 v[40:41], v53 offset:12288
    ds_read_b64_tr_b16 v[42:43], v53 offset:12800
    s_waitcnt lgkmcnt(9)
    v_mfma_f32_32x32x16_bf16 v[64:79], v[44:47], v[28:31], v[64:79]
    ds_read_b128 v[28:31], v115 offset:24576
    ds_read_b64_tr_b16 v[44:45], v53 offset:14336
    ds_read_b64_tr_b16 v[46:47], v53 offset:14848
    s_waitcnt lgkmcnt(9)
    v_mfma_f32_32x32x16_bf16 v[64:79], v[32:35], v[16:19], v[64:79]
    s_waitcnt vmcnt(4)
    s_barrier
    ds_read_b128 v[16:19], v112 offset:32768
    ds_read_b64_tr_b16 v[32:33], v52 offset:0
    ds_read_b64_tr_b16 v[34:35], v52 offset:512
    s_waitcnt lgkmcnt(9)
    v_mfma_f32_32x32x16_bf16 v[64:79], v[36:39], v[20:23], v[64:79]
    ds_read_b128 v[20:23], v113 offset:32768
    ds_read_b64_tr_b16 v[36:37], v52 offset:2048
    ds_read_b64_tr_b16 v[38:39], v52 offset:2560
    s_waitcnt lgkmcnt(9)
    v_mfma_f32_32x32x16_bf16 v[64:79], v[40:43], v[24:27], v[64:79]
    ds_read_b128 v[24:27], v114 offset:32768
    ds_read_b64_tr_b16 v[40:41], v52 offset:4096
    ds_read_b64_tr_b16 v[42:43], v52 offset:4608
    s_waitcnt lgkmcnt(9)
    v_mfma_f32_32x32x16_bf16 v[64:79], v[44:47], v[28:31], v[64:79]
    ds_read_b128 v[28:31], v115 offset:32768
    ds_read_b64_tr_b16 v[44:45], v52 offset:6144
    ds_read_b64_tr_b16 v[46:47], v52 offset:6656
    s_waitcnt lgkmcnt(9)
    v_mfma_f32_32x32x16_bf16 v[64:79], v[32:35], v[16:19], v[64:79]
    ds_read_b128 v[16:19], v112 offset:40960
    ds_read_b64_tr_b16 v[32:33], v52 offset:8192
    ds_read_b64_tr_b16 v[34:35], v52 offset:8704
    s_waitcnt lgkmcnt(9)
    v_mfma_f32_32x32x16_bf16 v[64:79], v[36:39], v[20:23], v[64:79]
    ds_read_b128 v[20:23], v113 offset:40960
    ds_read_b64_tr_b16 v[36:37], v52 offset:10240
    ds_read_b64_tr_b16 v[38:39], v52 offset:10752
    s_waitcnt lgkmcnt(9)
    v_mfma_f32_32x32x16_bf16 v[64:79], v[40:43], v[24:27], v[64:79]
    ds_read_b128 v[24:27], v114 offset:40960
    ds_read_b64_tr_b16 v[40:41], v52 offset:12288
    ds_read_b64_tr_b16 v[42:43], v52 offset:12800
    s_waitcnt lgkmcnt(9)
    v_mfma_f32_32x32x16_bf16 v[64:79], v[44:47], v[28:31], v[64:79]
    ds_read_b128 v[28:31], v115 offset:40960
    ds_read_b64_tr_b16 v[44:45], v52 offset:14336
    ds_read_b64_tr_b16 v[46:47], v52 offset:14848
    s_waitcnt lgkmcnt(9)
    v_mfma_f32_32x32x16_bf16 v[64:79], v[32:35], v[16:19], v[64:79]
    s_waitcnt vmcnt(0)
    s_barrier
    ds_read_b128 v[16:19], v112 offset:49152
    ds_read_b64_tr_b16 v[32:33], v52 offset:16384
    ds_read_b64_tr_b16 v[34:35], v52 offset:16896
    s_waitcnt lgkmcnt(9)
    v_mfma_f32_32x32x16_bf16 v[64:79], v[36:39], v[20:23], v[64:79]
    ds_read_b128 v[20:23], v113 offset:49152
    ds_read_b64_tr_b16 v[36:37], v52 offset:18432
    ds_read_b64_tr_b16 v[38:39], v52 offset:18944
    s_waitcnt lgkmcnt(9)
    v_mfma_f32_32x32x16_bf16 v[64:79], v[40:43], v[24:27], v[64:79]
    ds_read_b128 v[24:27], v114 offset:49152
    ds_read_b64_tr_b16 v[40:41], v52 offset:20480
    ds_read_b64_tr_b16 v[42:43], v52 offset:20992
    s_waitcnt lgkmcnt(9)
    v_mfma_f32_32x32x16_bf16 v[64:79], v[44:47], v[28:31], v[64:79]
    ds_read_b128 v[28:31], v115 offset:49152
    ds_read_b64_tr_b16 v[44:45], v52 offset:22528
    ds_read_b64_tr_b16 v[46:47], v52 offset:23040
    s_waitcnt lgkmcnt(9)
    v_mfma_f32_32x32x16_bf16 v[64:79], v[32:35], v[16:19], v[64:79]
    ds_read_b128 v[16:19], v112 offset:57344
    ds_read_b64_tr_b16 v[32:33], v52 offset:24576
    ds_read_b64_tr_b16 v[34:35], v52 offset:25088
    s_waitcnt lgkmcnt(9)
    v_mfma_f32_32x32x16_bf16 v[64:79], v[36:39], v[20:23], v[64:79]
    ds_read_b128 v[20:23], v113 offset:57344
    ds_read_b64_tr_b16 v[36:37], v52 offset:26624
    ds_read_b64_tr_b16 v[38:39], v52 offset:27136
    s_waitcnt lgkmcnt(9)
    v_mfma_f32_32x32x16_bf16 v[64:79], v[40:43], v[24:27], v[64:79]
    ds_read_b128 v[24:27], v114 offset:57344
    ds_read_b64_tr_b16 v[40:41], v52 offset:28672
    ds_read_b64_tr_b16 v[42:43], v52 offset:29184
    s_waitcnt lgkmcnt(9)
    v_mfma_f32_32x32x16_bf16 v[64:79], v[44:47], v[28:31], v[64:79]
    ds_read_b128 v[28:31], v115 offset:57344
    ds_read_b64_tr_b16 v[44:45], v52 offset:30720
    ds_read_b64_tr_b16 v[46:47], v52 offset:31232
    s_waitcnt lgkmcnt(9)
    v_mfma_f32_32x32x16_bf16 v[64:79], v[32:35], v[16:19], v[64:79]
    s_waitcnt lgkmcnt(6)
    v_mfma_f32_32x32x16_bf16 v[64:79], v[36:39], v[20:23], v[64:79]
    s_waitcnt lgkmcnt(3)
    v_mfma_f32_32x32x16_bf16 v[64:79], v[40:43], v[24:27], v[64:79]
    s_waitcnt lgkmcnt(0)
    v_mfma_f32_32x32x16_bf16 v[64:79], v[44:47], v[28:31], v[64:79]
    s_barrier
    ds_read_b128 v[156:159], v6 offset:2048
    s_waitcnt lgkmcnt(0)
    v_mfma_f32_32x32x16_bf16 v[64:79], v[156:159], v[164:167], v[64:79]
    s_nop 11
    v_mul_f32 v64, v64, v124
    v_mul_f32 v65, v65, v124
    v_cvt_pk_bf16_f32 v16, v64, v65
    v_mul_f32 v66, v66, v124
    v_mul_f32 v67, v67, v124
    v_cvt_pk_bf16_f32 v17, v66, v67
    v_mul_f32 v68, v68, v124
    v_mul_f32 v69, v69, v124
    v_cvt_pk_bf16_f32 v18, v68, v69
    v_mul_f32 v70, v70, v124
    v_mul_f32 v71, v71, v124
    v_cvt_pk_bf16_f32 v19, v70, v71
    v_min_u32 v16, -2, v16
    v_min_u32 v17, -2, v17
    v_min_u32 v18, -2, v18
    v_min_u32 v19, -2, v19
    buffer_store_dwordx4 v[16:19], v4, s[12:15], s46 offen sc1
    v_mul_f32 v72, v72, v124
    v_mul_f32 v73, v73, v124
    v_cvt_pk_bf16_f32 v20, v72, v73
    v_mul_f32 v74, v74, v124
    v_mul_f32 v75, v75, v124
    v_cvt_pk_bf16_f32 v21, v74, v75
    v_mul_f32 v76, v76, v124
    v_mul_f32 v77, v77, v124
    v_cvt_pk_bf16_f32 v22, v76, v77
    v_mul_f32 v78, v78, v124
    v_mul_f32 v79, v79, v124
    v_cvt_pk_bf16_f32 v23, v78, v79
    v_min_u32 v20, -2, v20
    v_min_u32 v21, -2, v21
    v_min_u32 v22, -2, v22
    v_min_u32 v23, -2, v23
    buffer_store_dwordx4 v[20:23], v4, s[12:15], s47 offen sc1
    s_mov_b32 s95, 0
    s_mov_b64 exec, -1
    s_branch k2_entry
k1_aux:
    s_lshl_b32 s38, s19, 6
    s_lshl_b32 s27, s20, 3
    s_add_u32 s38, s38, s27
    s_lshl_b32 s27, s18, 1
    s_add_u32 s38, s38, s27
    s_lshl_b32 s39, s38, 10
    s_add_u32 s40, s39, 1024
    v_lshlrev_b32 v4, 4, v122
    v_mov_b32 v3, 0
    s_or_b32 s42, s2, s18
    s_waitcnt lgkmcnt(0)
    s_mov_b64 s[8:9], s[6:7]
    s_mov_b32 s6, 0x200000
    s_mov_b32 s7, 0x20000
    s_mov_b64 s[54:55], s[92:93]
    s_mov_b64 s[12:13], s[94:95]
    s_cmp_lg_u32 s42, 0
    s_cbranch_scc1 k1_nononce
    s_or_b32 s56, s56, 1
    v_mov_b32 v5, s56
    s_mov_b64 exec, 1
    global_store_dword v3, v5, s[54:55] sc1
    s_mov_b64 exec, -1
k1_nononce:
    buffer_load_dwordx4 v[96:99], v4, s[4:7], s39 offen
    buffer_load_dwordx4 v[100:103], v4, s[4:7], s40 offen
    global_load_dwordx4 v[104:107], v4, s[52:53]
    v_mov_b32 v48, -1
    v_mov_b32 v49, -1
    v_lshlrev_b32 v5, 3, v122
    s_lshl_b32 s41, s2, 7
    s_lshl_b32 s42, s18, 5
    s_add_u32 s41, s41, s42
    s_add_u32 s41, s41, 0xa08000
    s_mov_b64 exec, 15
    buffer_store_dwordx2 v[48:49], v5, s[12:15], s41 offen sc1
    s_lshl_b32 s42, s2, 2
    s_add_u32 s42, s42, s18
    s_lshl_b32 s41, s42, 4
    s_add_u32 s41, s41, 0xa10000
    s_mov_b64 exec, 3
    buffer_store_dwordx2 v[48:49], v5, s[12:15], s41 offen sc1
    s_mov_b64 exec, 15
    s_mov_b64 exec, -1
    v_bfe_u32 v13, v122, 2, 2
    v_lshrrev_b32 v14, 5, v122
    v_lshl_add_u32 v12, v14, 3, v13
    v_mul_u32_u24 v12, 256, v12
    v_and_b32 v14, 16, v122
    v_lshl_add_u32 v12, v14, 1, v12
    v_and_b32 v14, 3, v122
    v_lshl_add_u32 v12, v14, 3, v12
    s_lshl_b32 s33, s18, 12
    s_add_u32 s33, s33, 65536
    v_add_u32 v12, s33, v12
    v_xor_b32 v14, 0, v13
    v_lshl_add_u32 v82, v14, 6, v12
    v_mov_b32 v86, v82
    v_xor_b32 v14, 1, v13
    v_lshl_add_u32 v83, v14, 6, v12
    v_mov_b32 v87, v83
    v_xor_b32 v14, 2, v13
    v_lshl_add_u32 v84, v14, 6, v12
    v_mov_b32 v88, v84
    v_xor_b32 v14, 3, v13
    v_lshl_add_u32 v85, v14, 6, v12
    v_mov_b32 v89, v85
    v_bfe_u32 v13, v122, 2, 2
    v_lshrrev_b32 v14, 5, v122
    v_lshl_add_u32 v12, v14, 3, v13
    v_mul_u32_u24 v12, 128, v12
    v_and_b32 v14, 16, v122
    v_lshl_add_u32 v12, v14, 1, v12
    v_and_b32 v14, 3, v122
    v_lshl_add_u32 v12, v14, 3, v12
    s_lshl_b32 s33, s18, 11
    s_add_u32 s33, s33, 65536
    v_lshrrev_b32 v13, 1, v13
    v_lshl_add_u32 v12, v13, 6, v12
    v_add_u32 v90, s33, v12
    v_xor_b32 v91, 64, v90
    v_add_u32 v92, 0x10000, v90
    v_add_u32 v93, 0x10000, v91
    v_and_b32 v13, 15, v122
    v_bfe_u32 v14, v122, 4, 1
    v_cmp_eq_u32 vcc, v13, v14
    v_mov_b32 v13, s34
    s_nop 0
    v_cndmask_b32 v52, 0, v13, vcc
    v_cndmask_b32 v53, 0, v13, vcc
    v_cndmask_b32 v54, 0, v13, vcc
    v_cndmask_b32 v55, 0, v13, vcc
    v_mov_b64 v[56:57], 0
    v_mov_b64 v[58:59], 0
    v_mov_b64 v[60:61], 0
    v_mov_b64 v[62:63], 0
    v_mov_b64 v[64:65], 0
    v_mov_b64 v[66:67], 0
    v_mov_b64 v[68:69], 0
    v_mov_b64 v[70:71], 0
    v_mov_b64 v[72:73], 0
    v_mov_b64 v[74:75], 0
    v_mov_b64 v[76:77], 0
    v_mov_b64 v[78:79], 0
    v_and_b32 v6, 31, v122
    s_and_b32 s27, s18, 1
    s_lshl_b32 s28, s27, 7
    s_add_u32 s28, s28, 147456
    v_lshl_add_u32 v7, v6, 2, s28
    v_lshlrev_b32 v8, 3, v6
    s_lshl_b32 s28, s18, 2
    s_add_u32 s28, s28, 147456
    v_add_u32 v9, s28, v4
    s_lshl_b32 s35, s19, 1
    s_add_u32 s35, s35, s27
    s_lshl_b32 s22, s35, 15
    s_lshl_b32 s47, s35, 8
    s_add_u32 s47, s47, 0xa14000
    s_mov_b32 s46, 0
    s_mov_b32 s51, 0
    s_mov_b32 s49, 0
    s_lshl_b32 s50, s38, 3
    s_add_u32 s50, s50, 0xa14000
    s_waitcnt vmcnt(2)
    v_mov_b32 v124, 0
    v_mov_b32 v125, 0
    v_dot2c_f32_bf16 v124, s34, v96
    v_dot2c_f32_bf16 v125, s34, v100
    v_dot2c_f32_bf16 v124, s34, v97
    v_dot2c_f32_bf16 v125, s34, v101
    v_dot2c_f32_bf16 v124, s34, v98
    v_dot2c_f32_bf16 v125, s34, v102
    v_dot2c_f32_bf16 v124, s34, v99
    v_dot2c_f32_bf16 v125, s34, v103
    v_lshlrev_b32 v140, 16, v96
    v_and_b32 v141, 0xffff0000, v96
    v_lshlrev_b32 v142, 16, v97
    v_and_b32 v143, 0xffff0000, v97
    v_lshlrev_b32 v144, 16, v98
    v_and_b32 v145, 0xffff0000, v98
    v_lshlrev_b32 v146, 16, v99
    v_and_b32 v147, 0xffff0000, v99
    v_lshlrev_b32 v148, 16, v100
    v_and_b32 v149, 0xffff0000, v100
    v_lshlrev_b32 v150, 16, v101
    v_and_b32 v151, 0xffff0000, v101
    v_lshlrev_b32 v152, 16, v102
    v_and_b32 v153, 0xffff0000, v102
    v_lshlrev_b32 v154, 16, v103
    v_and_b32 v155, 0xffff0000, v103
    v_add_f32_dpp v124, v124, v124 quad_perm:[1,0,3,2] row_mask:0xf bank_mask:0xf
    v_add_f32_dpp v125, v125, v125 quad_perm:[1,0,3,2] row_mask:0xf bank_mask:0xf
    s_nop 0
    v_add_f32_dpp v124, v124, v124 quad_perm:[2,3,0,1] row_mask:0xf bank_mask:0xf
    v_add_f32_dpp v125, v125, v125 quad_perm:[2,3,0,1] row_mask:0xf bank_mask:0xf
    s_nop 0
    v_add_f32_dpp v124, v124, v124 row_half_mirror row_mask:0xf bank_mask:0xf
    v_add_f32_dpp v125, v125, v125 row_half_mirror row_mask:0xf bank_mask:0xf
    s_nop 0
    v_add_f32_dpp v124, v124, v124 row_mirror row_mask:0xf bank_mask:0xf
    v_add_f32_dpp v125, v125, v125 row_mirror row_mask:0xf bank_mask:0xf
    s_nop 0
    v_add_f32_dpp v124, v124, v124 row_bcast:15 row_mask:0xa bank_mask:0xf
    v_add_f32_dpp v125, v125, v125 row_bcast:15 row_mask:0xa bank_mask:0xf
    s_nop 0
    v_add_f32_dpp v124, v124, v124 row_bcast:31 row_mask:0xc bank_mask:0xf
    v_add_f32_dpp v125, v125, v125 row_bcast:31 row_mask:0xc bank_mask:0xf
    v_readlane_b32 s41, v124, 63
    v_readlane_b32 s42, v125, 63
    v_mov_b32 v128, 0x3b000000
    v_mul_f32 v126, s41, v128
    v_mul_f32 v127, s42, v128
    v_mov_b32 v124, 0
    v_mov_b32 v125, 0
    v_sub_f32 v130, v140, v126
    v_sub_f32 v131, v148, v127
    v_fmac_f32 v124, v130, v130
    v_fmac_f32 v125, v131, v131
    v_sub_f32 v130, v141, v126
    v_sub_f32 v131, v149, v127
    v_fmac_f32 v124, v130, v130
    v_fmac_f32 v125, v131, v131
    v_sub_f32 v130, v142, v126
    v_sub_f32 v131, v150, v127
    v_fmac_f32 v124, v130, v130
    v_fmac_f32 v125, v131, v131
    v_sub_f32 v130, v143, v126
    v_sub_f32 v131, v151, v127
    v_fmac_f32 v124, v130, v130
    v_fmac_f32 v125, v131, v131
    v_sub_f32 v130, v144, v126
    v_sub_f32 v131, v152, v127
    v_fmac_f32 v124, v130, v130
    v_fmac_f32 v125, v131, v131
    v_sub_f32 v130, v145, v126
    v_sub_f32 v131, v153, v127
    v_fmac_f32 v124, v130, v130
    v_fmac_f32 v125, v131, v131
    v_sub_f32 v130, v146, v126
    v_sub_f32 v131, v154, v127
    v_fmac_f32 v124, v130, v130
    v_fmac_f32 v125, v131, v131
    v_sub_f32 v130, v147, v126
    v_sub_f32 v131, v155, v127
    v_fmac_f32 v124, v130, v130
    v_fmac_f32 v125, v131, v131
    global_load_dword v116, v3, s[54:55] sc1
    s_barrier
    ds_read_b64_tr_b16 v[16:17], v86 offset:0
    ds_read_b64_tr_b16 v[18:19], v86 offset:1024
    ds_read_b64_tr_b16 v[20:21], v87 offset:0
    ds_read_b64_tr_b16 v[22:23], v87 offset:1024
    ds_read_b64_tr_b16 v[24:25], v88 offset:0
    ds_read_b64_tr_b16 v[26:27], v88 offset:1024
    ds_read_b64_tr_b16 v[28:29], v89 offset:0
    ds_read_b64_tr_b16 v[30:31], v89 offset:1024
    s_add_u32 s46, s46, 16384
    s_cmp_eq_u32 s46, 81920
    s_cselect_b32 s46, 0, s46
    v_add_u32 v86, s46, v82
    v_add_u32 v87, s46, v83
    v_add_u32 v88, s46, v84
    v_add_u32 v89, s46, v85
    s_waitcnt lgkmcnt(6)
    v_mfma_f32_16x16x32_bf16 v[56:59], v[52:55], v[16:19], v[56:59]
    s_waitcnt lgkmcnt(4)
    v_mfma_f32_16x16x32_bf16 v[60:63], v[52:55], v[20:23], v[60:63]
    s_waitcnt lgkmcnt(2)
    v_mfma_f32_16x16x32_bf16 v[64:67], v[52:55], v[24:27], v[64:67]
    s_waitcnt lgkmcnt(0)
    v_mfma_f32_16x16x32_bf16 v[68:71], v[52:55], v[28:31], v[68:71]
    v_add_f32_dpp v124, v124, v124 quad_perm:[1,0,3,2] row_mask:0xf bank_mask:0xf
    v_add_f32_dpp v125, v125, v125 quad_perm:[1,0,3,2] row_mask:0xf bank_mask:0xf
    s_nop 0
    v_add_f32_dpp v124, v124, v124 quad_perm:[2,3,0,1] row_mask:0xf bank_mask:0xf
    v_add_f32_dpp v125, v125, v125 quad_perm:[2,3,0,1] row_mask:0xf bank_mask:0xf
    s_nop 0
    v_add_f32_dpp v124, v124, v124 row_half_mirror row_mask:0xf bank_mask:0xf
    v_add_f32_dpp v125, v125, v125 row_half_mirror row_mask:0xf bank_mask:0xf
    s_nop 0
    v_add_f32_dpp v124, v124, v124 row_mirror row_mask:0xf bank_mask:0xf
    v_add_f32_dpp v125, v125, v125 row_mirror row_mask:0xf bank_mask:0xf
    s_nop 0
    v_add_f32_dpp v124, v124, v124 row_bcast:15 row_mask:0xa bank_mask:0xf
    v_add_f32_dpp v125, v125, v125 row_bcast:15 row_mask:0xa bank_mask:0xf
    s_nop 0
    v_add_f32_dpp v124, v124, v124 row_bcast:31 row_mask:0xc bank_mask:0xf
    v_add_f32_dpp v125, v125, v125 row_bcast:31 row_mask:0xc bank_mask:0xf
    v_cvt_pk_bf16_f32 v126, v126, v126
    v_and_b32 v126, 0xffff0000, v126
    v_cvt_pk_bf16_f32 v127, v127, v127
    v_and_b32 v127, 0xffff0000, v127
    v_readlane_b32 s41, v124, 63
    v_readlane_b32 s42, v125, 63
    v_sub_f32 v140, v140, v126
    v_sub_f32 v141, v141, v126
    v_sub_f32 v142, v142, v126
    v_sub_f32 v143, v143, v126
    v_sub_f32 v144, v144, v126
    v_sub_f32 v145, v145, v126
    v_sub_f32 v146, v146, v126
    v_sub_f32 v147, v147, v126
    v_sub_f32 v148, v148, v127
    v_sub_f32 v149, v149, v127
    v_sub_f32 v150, v150, v127
    v_sub_f32 v151, v151, v127
    v_sub_f32 v152, v152, v127
    v_sub_f32 v153, v153, v127
    v_sub_f32 v154, v154, v127
    v_sub_f32 v155, v155, v127
    v_mul_f32 v124, s41, v128
    v_mul_f32 v125, s42, v128
    v_cvt_pk_bf16_f32 v124, v124, v124
    v_and_b32 v124, 0xffff0000, v124
    v_cvt_pk_bf16_f32 v125, v125, v125
    v_and_b32 v125, 0xffff0000, v125
    v_add_f32 v124, 0x3727c5ac, v124
    v_add_f32 v125, 0x3727c5ac, v125
    v_cvt_pk_bf16_f32 v124, v124, v124
    v_and_b32 v124, 0xffff0000, v124
    v_cvt_pk_bf16_f32 v125, v125, v125
    v_and_b32 v125, 0xffff0000, v125
    v_sqrt_f32 v124, v124
    v_sqrt_f32 v125, v125
    v_cvt_pk_bf16_f32 v108, v140, v141
    v_cvt_pk_bf16_f32 v109, v142, v143
    v_cvt_pk_bf16_f32 v110, v144, v145
    v_cvt_pk_bf16_f32 v111, v146, v147
    v_cvt_pk_bf16_f32 v112, v148, v149
    v_cvt_pk_bf16_f32 v113, v150, v151
    v_cvt_pk_bf16_f32 v114, v152, v153
    v_cvt_pk_bf16_f32 v115, v154, v155
    v_cvt_pk_bf16_f32 v124, v124, v124
    v_and_b32 v124, 0xffff0000, v124
    v_cvt_pk_bf16_f32 v125, v125, v125
    v_and_b32 v125, 0xffff0000, v125
    v_lshrrev_b32 v156, 16, v126
    v_lshrrev_b32 v158, 16, v127
    v_or_b32 v156, v156, v124
    v_or_b32 v158, v158, v125
    v_rcp_f32 v124, v124
    v_rcp_f32 v125, v125
    s_cmp_lg_u32 s49, 0
    s_cbranch_scc1 k1_pubd_4
    s_mov_b32 s48, 0
k1_puba_5:
    s_waitcnt vmcnt(0)
    v_readfirstlane_b32 s49, v116
    s_add_u32 s51, s51, 1
    s_sub_u32 s27, s56, s49
    s_add_u32 s27, s27, 1000
    s_cmp_lt_u32 s27, 2000
    s_cselect_b32 s27, 99, s51
    s_cmp_ge_u32 s27, 8
    s_cselect_b32 s49, s49, 0
    s_cmp_lg_u32 s49, 0
    s_cbranch_scc1 k1_pubg_6
    global_load_dword v116, v3, s[54:55] sc1
    s_branch k1_pubd_4
k1_pubg_6:
    v_mov_b32 v157, s49
    v_mov_b32 v159, s49
    s_mov_b64 exec, 1
    buffer_store_dwordx4 v[156:159], v3, s[12:15], s50 offen sc1
    s_mov_b64 exec, -1
k1_pubd_4:
    s_barrier
    ds_read_b64_tr_b16 v[16:17], v86 offset:0
    ds_read_b64_tr_b16 v[18:19], v86 offset:1024
    ds_read_b64_tr_b16 v[20:21], v87 offset:0
    ds_read_b64_tr_b16 v[22:23], v87 offset:1024
    ds_read_b64_tr_b16 v[24:25], v88 offset:0
    ds_read_b64_tr_b16 v[26:27], v88 offset:1024
    ds_read_b64_tr_b16 v[28:29], v89 offset:0
    ds_read_b64_tr_b16 v[30:31], v89 offset:1024
    s_add_u32 s46, s46, 16384
    s_cmp_eq_u32 s46, 81920
    s_cselect_b32 s46, 0, s46
    v_add_u32 v86, s46, v82
    v_add_u32 v87, s46, v83
    v_add_u32 v88, s46, v84
    v_add_u32 v89, s46, v85
    s_waitcnt lgkmcnt(6)
    v_mfma_f32_16x16x32_bf16 v[56:59], v[52:55], v[16:19], v[56:59]
    s_waitcnt lgkmcnt(4)
    v_mfma_f32_16x16x32_bf16 v[60:63], v[52:55], v[20:23], v[60:63]
    s_waitcnt lgkmcnt(2)
    v_mfma_f32_16x16x32_bf16 v[64:67], v[52:55], v[24:27], v[64:67]
    s_waitcnt lgkmcnt(0)
    v_mfma_f32_16x16x32_bf16 v[68:71], v[52:55], v[28:31], v[68:71]
    v_lshlrev_b32 v140, 16, v108
    v_and_b32 v141, 0xffff0000, v108
    v_lshlrev_b32 v142, 16, v109
    v_and_b32 v143, 0xffff0000, v109
    v_lshlrev_b32 v144, 16, v110
    v_and_b32 v145, 0xffff0000, v110
    v_lshlrev_b32 v146, 16, v111
    v_and_b32 v147, 0xffff0000, v111
    v_lshlrev_b32 v148, 16, v112
    v_and_b32 v149, 0xffff0000, v112
    v_lshlrev_b32 v150, 16, v113
    v_and_b32 v151, 0xffff0000, v113
    v_lshlrev_b32 v152, 16, v114
    v_and_b32 v153, 0xffff0000, v114
    v_lshlrev_b32 v154, 16, v115
    v_and_b32 v155, 0xffff0000, v115
    v_mul_f32 v140, v140, v124
    v_mul_f32 v141, v141, v124
    v_mul_f32 v142, v142, v124
    v_mul_f32 v143, v143, v124
    v_mul_f32 v144, v144, v124
    v_mul_f32 v145, v145, v124
    v_mul_f32 v146, v146, v124
    v_mul_f32 v147, v147, v124
    v_mul_f32 v148, v148, v125
    v_mul_f32 v149, v149, v125
    v_mul_f32 v150, v150, v125
    v_mul_f32 v151, v151, v125
    v_mul_f32 v152, v152, v125
    v_mul_f32 v153, v153, v125
    v_mul_f32 v154, v154, v125
    v_mul_f32 v155, v155, v125
    v_cvt_pk_bf16_f32 v108, v140, v141
    v_cvt_pk_bf16_f32 v109, v142, v143
    v_cvt_pk_bf16_f32 v110, v144, v145
    v_cvt_pk_bf16_f32 v111, v146, v147
    v_cvt_pk_bf16_f32 v112, v148, v149
    v_cvt_pk_bf16_f32 v113, v150, v151
    v_cvt_pk_bf16_f32 v114, v152, v153
    v_cvt_pk_bf16_f32 v115, v154, v155
    s_cmp_lg_u32 s49, 0
    s_cbranch_scc1 k1_pubd_7
    s_mov_b32 s48, 0
k1_puba_8:
    s_waitcnt vmcnt(0)
    v_readfirstlane_b32 s49, v116
    s_add_u32 s51, s51, 1
    s_sub_u32 s27, s56, s49
    s_add_u32 s27, s27, 1000
    s_cmp_lt_u32 s27, 2000
    s_cselect_b32 s27, 99, s51
    s_cmp_ge_u32 s27, 8
    s_cselect_b32 s49, s49, 0
    s_cmp_lg_u32 s49, 0
    s_cbranch_scc1 k1_pubg_9
    global_load_dword v116, v3, s[54:55] sc1
    s_add_u32 s48, s48, 1
    s_cmp_lt_u32 s48, 16384
    s_cbranch_scc1 k1_puba_8
    s_branch k1_pubd_7
k1_pubg_9:
    v_mov_b32 v157, s49
    v_mov_b32 v159, s49
    s_mov_b64 exec, 1
    buffer_store_dwordx4 v[156:159], v3, s[12:15], s50 offen sc1
    s_mov_b64 exec, -1
k1_pubd_7:
    s_barrier
    ds_read_b64_tr_b16 v[16:17], v86 offset:0
    ds_read_b64_tr_b16 v[18:19], v86 offset:1024
    ds_read_b64_tr_b16 v[20:21], v87 offset:0
    ds_read_b64_tr_b16 v[22:23], v87 offset:1024
    ds_read_b64_tr_b16 v[24:25], v88 offset:0
    ds_read_b64_tr_b16 v[26:27], v88 offset:1024
    ds_read_b64_tr_b16 v[28:29], v89 offset:0
    ds_read_b64_tr_b16 v[30:31], v89 offset:1024
    s_add_u32 s46, s46, 16384
    s_cmp_eq_u32 s46, 81920
    s_cselect_b32 s46, 0, s46
    v_add_u32 v86, s46, v82
    v_add_u32 v87, s46, v83
    v_add_u32 v88, s46, v84
    v_add_u32 v89, s46, v85
    s_waitcnt lgkmcnt(6)
    v_mfma_f32_16x16x32_bf16 v[56:59], v[52:55], v[16:19], v[56:59]
    s_waitcnt lgkmcnt(4)
    v_mfma_f32_16x16x32_bf16 v[60:63], v[52:55], v[20:23], v[60:63]
    s_waitcnt lgkmcnt(2)
    v_mfma_f32_16x16x32_bf16 v[64:67], v[52:55], v[24:27], v[64:67]
    s_waitcnt lgkmcnt(0)
    v_mfma_f32_16x16x32_bf16 v[68:71], v[52:55], v[28:31], v[68:71]
    v_mov_b32 v124, 0
    v_mov_b32 v125, 0
    v_dot2c_f32_bf16 v124, v108, v104
    v_dot2c_f32_bf16 v125, v112, v104
    v_dot2c_f32_bf16 v124, v109, v105
    v_dot2c_f32_bf16 v125, v113, v105
    v_dot2c_f32_bf16 v124, v110, v106
    v_dot2c_f32_bf16 v125, v114, v106
    v_dot2c_f32_bf16 v124, v111, v107
    v_dot2c_f32_bf16 v125, v115, v107
    s_nop 1
    v_add_f32_dpp v124, v124, v124 quad_perm:[1,0,3,2] row_mask:0xf bank_mask:0xf
    v_add_f32_dpp v125, v125, v125 quad_perm:[1,0,3,2] row_mask:0xf bank_mask:0xf
    s_nop 0
    v_add_f32_dpp v124, v124, v124 quad_perm:[2,3,0,1] row_mask:0xf bank_mask:0xf
    v_add_f32_dpp v125, v125, v125 quad_perm:[2,3,0,1] row_mask:0xf bank_mask:0xf
    s_nop 0
    v_add_f32_dpp v124, v124, v124 row_half_mirror row_mask:0xf bank_mask:0xf
    v_add_f32_dpp v125, v125, v125 row_half_mirror row_mask:0xf bank_mask:0xf
    s_nop 0
    v_add_f32_dpp v124, v124, v124 row_mirror row_mask:0xf bank_mask:0xf
    v_add_f32_dpp v125, v125, v125 row_mirror row_mask:0xf bank_mask:0xf
    s_nop 0
    v_add_f32_dpp v124, v124, v124 row_bcast:15 row_mask:0xa bank_mask:0xf
    v_add_f32_dpp v125, v125, v125 row_bcast:15 row_mask:0xa bank_mask:0xf
    s_nop 0
    v_add_f32_dpp v124, v124, v124 row_bcast:31 row_mask:0xc bank_mask:0xf
    v_add_f32_dpp v125, v125, v125 row_bcast:31 row_mask:0xc bank_mask:0xf
    v_cvt_pk_bf16_f32 v124, v124, v125
    s_cmp_lg_u32 s49, 0
    s_cbranch_scc1 k1_pubd_10
    s_mov_b32 s48, 0
k1_puba_11:
    s_waitcnt vmcnt(0)
    v_readfirstlane_b32 s49, v116
    s_add_u32 s51, s51, 1
    s_sub_u32 s27, s56, s49
    s_add_u32 s27, s27, 1000
    s_cmp_lt_u32 s27, 2000
    s_cselect_b32 s27, 99, s51
    s_cmp_ge_u32 s27, 8
    s_cselect_b32 s49, s49, 0
    s_cmp_lg_u32 s49, 0
    s_cbranch_scc1 k1_pubg_12
    global_load_dword v116, v3, s[54:55] sc1
    s_branch k1_pubd_10
k1_pubg_12:
    v_mov_b32 v157, s49
    v_mov_b32 v159, s49
    s_mov_b64 exec, 1
    buffer_store_dwordx4 v[156:159], v3, s[12:15], s50 offen sc1
    s_mov_b64 exec, -1
k1_pubd_10:
    s_barrier
    ds_read_b64_tr_b16 v[16:17], v86 offset:0
    ds_read_b64_tr_b16 v[18:19], v86 offset:1024
    ds_read_b64_tr_b16 v[20:21], v87 offset:0
    ds_read_b64_tr_b16 v[22:23], v87 offset:1024
    ds_read_b64_tr_b16 v[24:25], v88 offset:0
    ds_read_b64_tr_b16 v[26:27], v88 offset:1024
    ds_read_b64_tr_b16 v[28:29], v89 offset:0
    ds_read_b64_tr_b16 v[30:31], v89 offset:1024
    s_add_u32 s46, s46, 16384
    s_cmp_eq_u32 s46, 81920
    s_cselect_b32 s46, 0, s46
    v_add_u32 v86, s46, v82
    v_add_u32 v87, s46, v83
    v_add_u32 v88, s46, v84
    v_add_u32 v89, s46, v85
    s_waitcnt lgkmcnt(6)
    v_mfma_f32_16x16x32_bf16 v[56:59], v[52:55], v[16:19], v[56:59]
    s_waitcnt lgkmcnt(4)
    v_mfma_f32_16x16x32_bf16 v[60:63], v[52:55], v[20:23], v[60:63]
    s_waitcnt lgkmcnt(2)
    v_mfma_f32_16x16x32_bf16 v[64:67], v[52:55], v[24:27], v[64:67]
    s_waitcnt lgkmcnt(0)
    v_mfma_f32_16x16x32_bf16 v[68:71], v[52:55], v[28:31], v[68:71]
    v_readlane_b32 s41, v124, 63
    s_lshl_b32 s42, s41, 16
    s_ashr_i32 s43, s42, 31
    s_and_b32 s43, s43, 0x7fff0000
    s_xor_b32 s42, s42, s43
    s_xor_b32 s42, s42, 0x80000000
    s_sub_u32 s43, 34815, s38
    s_or_b32 s42, s42, s43
    v_mov_b32 v126, s42
    s_and_b32 s42, s41, 0xffff0000
    s_ashr_i32 s43, s42, 31
    s_and_b32 s43, s43, 0x7fff0000
    s_xor_b32 s42, s42, s43
    s_xor_b32 s42, s42, 0x80000000
    s_sub_u32 s43, 34814, s38
    s_or_b32 s42, s42, s43
    v_mov_b32 v127, s42
    v_mov_b32 v156, v126
    v_mov_b32 v157, s49
    v_mov_b32 v158, v127
    v_mov_b32 v159, s49
    s_lshl_b32 s41, s38, 3
    s_add_u32 s41, s41, 0xa18000
    s_mov_b64 exec, 1
    buffer_store_dwordx4 v[156:159], v3, s[12:15], s41 offen sc1
    s_mov_b64 exec, -1
    s_barrier
    ds_read_b64_tr_b16 v[16:17], v86 offset:0
    ds_read_b64_tr_b16 v[18:19], v86 offset:1024
    ds_read_b64_tr_b16 v[20:21], v87 offset:0
    ds_read_b64_tr_b16 v[22:23], v87 offset:1024
    ds_read_b64_tr_b16 v[24:25], v88 offset:0
    ds_read_b64_tr_b16 v[26:27], v88 offset:1024
    ds_read_b64_tr_b16 v[28:29], v89 offset:0
    ds_read_b64_tr_b16 v[30:31], v89 offset:1024
    s_add_u32 s46, s46, 16384
    s_cmp_eq_u32 s46, 81920
    s_cselect_b32 s46, 0, s46
    v_add_u32 v86, s46, v82
    v_add_u32 v87, s46, v83
    v_add_u32 v88, s46, v84
    v_add_u32 v89, s46, v85
    s_waitcnt lgkmcnt(6)
    v_mfma_f32_16x16x32_bf16 v[56:59], v[52:55], v[16:19], v[56:59]
    s_waitcnt lgkmcnt(4)
    v_mfma_f32_16x16x32_bf16 v[60:63], v[52:55], v[20:23], v[60:63]
    s_waitcnt lgkmcnt(2)
    v_mfma_f32_16x16x32_bf16 v[64:67], v[52:55], v[24:27], v[64:67]
    s_waitcnt lgkmcnt(0)
    v_mfma_f32_16x16x32_bf16 v[68:71], v[52:55], v[28:31], v[68:71]
    buffer_load_dwordx2 v[118:119], v8, s[12:15], s47 offen sc1
    s_barrier
    ds_read_b64_tr_b16 v[16:17], v86 offset:0
    ds_read_b64_tr_b16 v[18:19], v86 offset:1024
    ds_read_b64_tr_b16 v[20:21], v87 offset:0
    ds_read_b64_tr_b16 v[22:23], v87 offset:1024
    ds_read_b64_tr_b16 v[24:25], v88 offset:0
    ds_read_b64_tr_b16 v[26:27], v88 offset:1024
    ds_read_b64_tr_b16 v[28:29], v89 offset:0
    ds_read_b64_tr_b16 v[30:31], v89 offset:1024
    s_add_u32 s46, s46, 16384
    s_cmp_eq_u32 s46, 81920
    s_cselect_b32 s46, 0, s46
    v_add_u32 v86, s46, v82
    v_add_u32 v87, s46, v83
    v_add_u32 v88, s46, v84
    v_add_u32 v89, s46, v85
    s_waitcnt lgkmcnt(6)
    v_mfma_f32_16x16x32_bf16 v[56:59], v[52:55], v[16:19], v[56:59]
    s_waitcnt lgkmcnt(4)
    v_mfma_f32_16x16x32_bf16 v[60:63], v[52:55], v[20:23], v[60:63]
    s_waitcnt lgkmcnt(2)
    v_mfma_f32_16x16x32_bf16 v[64:67], v[52:55], v[24:27], v[64:67]
    s_waitcnt lgkmcnt(0)
    v_mfma_f32_16x16x32_bf16 v[68:71], v[52:55], v[28:31], v[68:71]
    s_barrier
    ds_read_b64_tr_b16 v[16:17], v86 offset:0
    ds_read_b64_tr_b16 v[18:19], v86 offset:1024
    ds_read_b64_tr_b16 v[20:21], v87 offset:0
    ds_read_b64_tr_b16 v[22:23], v87 offset:1024
    ds_read_b64_tr_b16 v[24:25], v88 offset:0
    ds_read_b64_tr_b16 v[26:27], v88 offset:1024
    ds_read_b64_tr_b16 v[28:29], v89 offset:0
    ds_read_b64_tr_b16 v[30:31], v89 offset:1024
    s_add_u32 s46, s46, 16384
    s_cmp_eq_u32 s46, 81920
    s_cselect_b32 s46, 0, s46
    v_add_u32 v86, s46, v82
    v_add_u32 v87, s46, v83
    v_add_u32 v88, s46, v84
    v_add_u32 v89, s46, v85
    s_waitcnt lgkmcnt(6)
    v_mfma_f32_16x16x32_bf16 v[56:59], v[52:55], v[16:19], v[56:59]
    s_waitcnt lgkmcnt(4)
    v_mfma_f32_16x16x32_bf16 v[60:63], v[52:55], v[20:23], v[60:63]
    s_waitcnt lgkmcnt(2)
    v_mfma_f32_16x16x32_bf16 v[64:67], v[52:55], v[24:27], v[64:67]
    s_waitcnt lgkmcnt(0)
    v_mfma_f32_16x16x32_bf16 v[68:71], v[52:55], v[28:31], v[68:71]
    s_barrier
    ds_read_b64_tr_b16 v[16:17], v86 offset:0
    ds_read_b64_tr_b16 v[18:19], v86 offset:1024
    ds_read_b64_tr_b16 v[20:21], v87 offset:0
    ds_read_b64_tr_b16 v[22:23], v87 offset:1024
    ds_read_b64_tr_b16 v[24:25], v88 offset:0
    ds_read_b64_tr_b16 v[26:27], v88 offset:1024
    ds_read_b64_tr_b16 v[28:29], v89 offset:0
    ds_read_b64_tr_b16 v[30:31], v89 offset:1024
    s_mov_b32 s48, 0
k1_gpoll:
    s_waitcnt vmcnt(0)
    v_cmp_ne_u32 vcc, s49, v119
    s_cbranch_vccz k1_ggot
    buffer_load_dwordx2 v[118:119], v8, s[12:15], s47 offen sc1
    s_add_u32 s48, s48, 1
    s_cmp_lt_u32 s48, 16384
    s_cbranch_scc1 k1_gpoll
    s_branch k1_local
k1_ggot:
    s_cmp_eq_u32 s49, 0
    s_cbranch_scc1 k1_local
k1_have:
    v_and_b32 v10, 0xffff0000, v118
    v_and_b32 v11, 0xffff, v118
    v_rcp_f32 v10, v10
    v_xor_b32 v11, 0x8000, v11
    v_lshl_or_b32 v11, v11, 16, v11
    ds_write_b32 v7, v10 offset:3072
    ds_write_b32 v7, v11 offset:3328
    s_waitcnt lgkmcnt(2)
    v_mfma_f32_16x16x32_bf16 v[56:59], v[52:55], v[16:19], v[56:59]
    v_mfma_f32_16x16x32_bf16 v[60:63], v[52:55], v[20:23], v[60:63]
    v_mfma_f32_16x16x32_bf16 v[64:67], v[52:55], v[24:27], v[64:67]
    v_mfma_f32_16x16x32_bf16 v[68:71], v[52:55], v[28:31], v[68:71]
    v_mov_b32 v12, 163776
    v_mov_b32 v13, s49
    v_lshl_add_u32 v14, s18, 3, v12
    ds_write_b32 v12, v13
    ds_write_b32 v12, v3 offset:4
    ds_write_b64 v14, v[126:127] offset:16
    v_and_b32 v58, 0xffff0000, v56
    v_and_b32 v59, 0xffff0000, v57
    v_and_b32 v62, 0xffff0000, v60
    v_and_b32 v63, 0xffff0000, v61
    v_and_b32 v66, 0xffff0000, v64
    v_and_b32 v67, 0xffff0000, v65
    v_and_b32 v70, 0xffff0000, v68
    v_and_b32 v71, 0xffff0000, v69
    v_sub_f32 v56, v56, v58
    v_sub_f32 v57, v57, v59
    v_sub_f32 v60, v60, v62
    v_sub_f32 v61, v61, v63
    v_sub_f32 v64, v64, v66
    v_sub_f32 v65, v65, v67
    v_sub_f32 v68, v68, v70
    v_sub_f32 v69, v69, v71
    v_cvt_pk_bf16_f32 v56, v58, v56
    v_cvt_pk_bf16_f32 v57, v59, v57
    v_cvt_pk_bf16_f32 v60, v62, v60
    v_cvt_pk_bf16_f32 v61, v63, v61
    v_cvt_pk_bf16_f32 v64, v66, v64
    v_cvt_pk_bf16_f32 v65, v67, v65
    v_cvt_pk_bf16_f32 v68, v70, v68
    v_cvt_pk_bf16_f32 v69, v71, v69
    s_mov_b64 exec, 0xffff
    ds_write_b32 v9, v56 offset:0
    ds_write_b32 v9, v57 offset:256
    ds_write_b32 v9, v60 offset:512
    ds_write_b32 v9, v61 offset:768
    ds_write_b32 v9, v64 offset:1024
    ds_write_b32 v9, v65 offset:1280
    ds_write_b32 v9, v68 offset:1536
    ds_write_b32 v9, v69 offset:1792
    s_mov_b64 exec, -1
    s_waitcnt lgkmcnt(0)
    s_barrier
    ds_read_b64_tr_b16 v[16:17], v90 offset:49152
    ds_read_b64_tr_b16 v[18:19], v90 offset:49664
    ds_read_b64_tr_b16 v[20:21], v91 offset:49152
    ds_read_b64_tr_b16 v[22:23], v91 offset:49664
    ds_read_b64_tr_b16 v[24:25], v90 offset:57344
    ds_read_b64_tr_b16 v[26:27], v90 offset:57856
    ds_read_b64_tr_b16 v[28:29], v91 offset:57344
    ds_read_b64_tr_b16 v[30:31], v91 offset:57856
    s_waitcnt lgkmcnt(6)
    v_mfma_f32_16x16x32_bf16 v[72:75], v[52:55], v[16:19], v[72:75]
    s_waitcnt lgkmcnt(4)
    v_mfma_f32_16x16x32_bf16 v[76:79], v[52:55], v[20:23], v[76:79]
    s_waitcnt lgkmcnt(2)
    v_mfma_f32_16x16x32_bf16 v[72:75], v[52:55], v[24:27], v[72:75]
    s_waitcnt lgkmcnt(0)
    v_mfma_f32_16x16x32_bf16 v[76:79], v[52:55], v[28:31], v[76:79]
    s_and_b32 s28, s26, 3
    s_lshl_b32 s29, s25, 2
    s_add_u32 s28, s28, s29
    s_lshr_b32 s29, s26, 2
    v_and_b32 v12, 15, v122
    v_cmp_gt_u32 vcc, 4, v12
    v_subrev_u32 v13, 4, v12
    v_cmp_gt_u32 s[30:31], 10, v12
    v_subrev_u32 v14, 10, v12
    s_nop 0
    v_cndmask_b32 v13, v14, v13, s[30:31]
    s_lshr_b32 s42, s28, 3
    s_add_u32 s43, s42, 4
    v_mov_b32 v14, s43
    v_mov_b32 v15, s42
    v_cndmask_b32 v14, v14, v15, s[30:31]
    v_lshl_add_u32 v12, s29, 2, v12
    s_lshr_b32 s42, s28, 2
    v_mov_b32 v15, s42
    v_cndmask_b32 v13, v13, v12, vcc
    v_cndmask_b32 v14, v14, v15, vcc
    v_lshlrev_b32 v13, 9, v13
    v_lshl_add_u32 v119, v14, 6, v13
    s_mov_b32 s42, 0xa18000
    buffer_load_dword v116, v119, s[12:15], s42 offen offset:4 sc1
    s_barrier
    ds_read_b64_tr_b16 v[16:17], v92 offset:0
    ds_read_b64_tr_b16 v[18:19], v92 offset:512
    ds_read_b64_tr_b16 v[20:21], v93 offset:0
    ds_read_b64_tr_b16 v[22:23], v93 offset:512
    ds_read_b64_tr_b16 v[24:25], v92 offset:8192
    ds_read_b64_tr_b16 v[26:27], v92 offset:8704
    ds_read_b64_tr_b16 v[28:29], v93 offset:8192
    ds_read_b64_tr_b16 v[30:31], v93 offset:8704
    s_waitcnt lgkmcnt(6)
    v_mfma_f32_16x16x32_bf16 v[72:75], v[52:55], v[16:19], v[72:75]
    s_waitcnt lgkmcnt(4)
    v_mfma_f32_16x16x32_bf16 v[76:79], v[52:55], v[20:23], v[76:79]
    s_waitcnt lgkmcnt(2)
    v_mfma_f32_16x16x32_bf16 v[72:75], v[52:55], v[24:27], v[72:75]
    s_waitcnt lgkmcnt(0)
    v_mfma_f32_16x16x32_bf16 v[76:79], v[52:55], v[28:31], v[76:79]
    s_barrier
    ds_read_b64_tr_b16 v[16:17], v90 offset:0
    ds_read_b64_tr_b16 v[18:19], v90 offset:512
    ds_read_b64_tr_b16 v[20:21], v91 offset:0
    ds_read_b64_tr_b16 v[22:23], v91 offset:512
    ds_read_b64_tr_b16 v[24:25], v90 offset:8192
    ds_read_b64_tr_b16 v[26:27], v90 offset:8704
    ds_read_b64_tr_b16 v[28:29], v91 offset:8192
    ds_read_b64_tr_b16 v[30:31], v91 offset:8704
    s_waitcnt lgkmcnt(6)
    v_mfma_f32_16x16x32_bf16 v[72:75], v[52:55], v[16:19], v[72:75]
    s_waitcnt lgkmcnt(4)
    v_mfma_f32_16x16x32_bf16 v[76:79], v[52:55], v[20:23], v[76:79]
    s_waitcnt lgkmcnt(2)
    v_mfma_f32_16x16x32_bf16 v[72:75], v[52:55], v[24:27], v[72:75]
    s_waitcnt lgkmcnt(0)
    v_mfma_f32_16x16x32_bf16 v[76:79], v[52:55], v[28:31], v[76:79]
    s_barrier
    ds_read_b64_tr_b16 v[16:17], v90 offset:16384
    ds_read_b64_tr_b16 v[18:19], v90 offset:16896
    ds_read_b64_tr_b16 v[20:21], v91 offset:16384
    ds_read_b64_tr_b16 v[22:23], v91 offset:16896
    ds_read_b64_tr_b16 v[24:25], v90 offset:24576
    ds_read_b64_tr_b16 v[26:27], v90 offset:25088
    ds_read_b64_tr_b16 v[28:29], v91 offset:24576
    ds_read_b64_tr_b16 v[30:31], v91 offset:25088
    s_waitcnt lgkmcnt(6)
    v_mfma_f32_16x16x32_bf16 v[72:75], v[52:55], v[16:19], v[72:75]
    s_waitcnt lgkmcnt(4)
    v_mfma_f32_16x16x32_bf16 v[76:79], v[52:55], v[20:23], v[76:79]
    s_waitcnt lgkmcnt(2)
    v_mfma_f32_16x16x32_bf16 v[72:75], v[52:55], v[24:27], v[72:75]
    s_waitcnt lgkmcnt(0)
    v_mfma_f32_16x16x32_bf16 v[76:79], v[52:55], v[28:31], v[76:79]
    s_nop 5
    v_and_b32 v74, 0xffff0000, v72
    v_and_b32 v75, 0xffff0000, v73
    v_and_b32 v78, 0xffff0000, v76
    v_and_b32 v79, 0xffff0000, v77
    v_sub_f32 v72, v72, v74
    v_sub_f32 v73, v73, v75
    v_sub_f32 v76, v76, v78
    v_sub_f32 v77, v77, v79
    v_cvt_pk_bf16_f32 v72, v74, v72
    v_cvt_pk_bf16_f32 v73, v75, v73
    v_cvt_pk_bf16_f32 v76, v78, v76
    v_cvt_pk_bf16_f32 v77, v79, v77
    s_mov_b64 exec, 0xffff
    ds_write_b32 v9, v72 offset:2048
    ds_write_b32 v9, v73 offset:2304
    ds_write_b32 v9, v76 offset:2560
    ds_write_b32 v9, v77 offset:2816
    s_mov_b64 exec, -1
    s_waitcnt lgkmcnt(0)
    s_barrier
    s_mov_b32 s97, s49
    s_mov_b32 s99, s38
    s_mov_b64 exec, -1
    s_branch k2_entry
k1_local:
    s_waitcnt vmcnt(0)
    v_lshrrev_b32 v14, 5, v122
    v_lshlrev_b32 v15, 10, v6
    v_lshl_add_u32 v15, v14, 9, v15
    v_mov_b32 v10, 0
    v_mov_b32 v14, 0
    s_mov_b32 s27, s22
    s_add_u32 s28, s22, 512
k1_loc_0:
    buffer_load_dwordx4 v[96:99], v15, s[4:7], s27 offen
    s_waitcnt vmcnt(0)
    v_lshlrev_b32 v12, 16, v96
    v_and_b32 v13, 0xffff0000, v96
    v_add_f32 v14, v14, v12
    v_add_f32 v14, v14, v13
    v_lshlrev_b32 v12, 16, v97
    v_and_b32 v13, 0xffff0000, v97
    v_add_f32 v14, v14, v12
    v_add_f32 v14, v14, v13
    v_lshlrev_b32 v12, 16, v98
    v_and_b32 v13, 0xffff0000, v98
    v_add_f32 v14, v14, v12
    v_add_f32 v14, v14, v13
    v_lshlrev_b32 v12, 16, v99
    v_and_b32 v13, 0xffff0000, v99
    v_add_f32 v14, v14, v12
    v_add_f32 v14, v14, v13
    s_add_u32 s27, s27, 16
    s_cmp_lt_u32 s27, s28
    s_cbranch_scc1 k1_loc_0
    v_mov_b32 v12, v14
    s_nop 1
    v_permlane32_swap_b32 v12, v14
    v_add_f32 v14, v14, v12
    v_mul_f32 v10, 0x3b000000, v14
    v_mov_b32 v14, 0
    s_mov_b32 s27, s22
    s_add_u32 s28, s22, 512
k1_loc_1:
    buffer_load_dwordx4 v[96:99], v15, s[4:7], s27 offen
    s_waitcnt vmcnt(0)
    v_lshlrev_b32 v12, 16, v96
    v_and_b32 v13, 0xffff0000, v96
    v_sub_f32 v12, v12, v10
    v_sub_f32 v13, v13, v10
    v_fmac_f32 v14, v12, v12
    v_fmac_f32 v14, v13, v13
    v_lshlrev_b32 v12, 16, v97
    v_and_b32 v13, 0xffff0000, v97
    v_sub_f32 v12, v12, v10
    v_sub_f32 v13, v13, v10
    v_fmac_f32 v14, v12, v12
    v_fmac_f32 v14, v13, v13
    v_lshlrev_b32 v12, 16, v98
    v_and_b32 v13, 0xffff0000, v98
    v_sub_f32 v12, v12, v10
    v_sub_f32 v13, v13, v10
    v_fmac_f32 v14, v12, v12
    v_fmac_f32 v14, v13, v13
    v_lshlrev_b32 v12, 16, v99
    v_and_b32 v13, 0xffff0000, v99
    v_sub_f32 v12, v12, v10
    v_sub_f32 v13, v13, v10
    v_fmac_f32 v14, v12, v12
    v_fmac_f32 v14, v13, v13
    s_add_u32 s27, s27, 16
    s_cmp_lt_u32 s27, s28
    s_cbranch_scc1 k1_loc_1
    v_mov_b32 v12, v14
    s_nop 1
    v_permlane32_swap_b32 v12, v14
    v_add_f32 v14, v14, v12
    v_mul_f32 v11, 0x3b000000, v14
    v_cvt_pk_bf16_f32 v11, v11, v11
    v_and_b32 v11, 0xffff0000, v11
    v_add_f32 v11, 0x3727c5ac, v11
    v_cvt_pk_bf16_f32 v11, v11, v11
    v_and_b32 v11, 0xffff0000, v11
    v_sqrt_f32 v11, v11
    s_nop 0
    v_cvt_pk_bf16_f32 v11, v11, v11
    v_and_b32 v11, 0xffff0000, v11
    v_cvt_pk_bf16_f32 v10, v10, v10
    v_and_b32 v10, 0xffff0000, v10
    v_lshrrev_b32 v10, 16, v10
    v_or_b32 v118, v10, v11
    s_branch k1_have
k1_end:
    s_endpgm
k2_entry:
    s_load_dwordx2 s[4:5], s[0:1], 80
    s_load_dwordx4 s[8:11], s[0:1], 40
    s_load_dwordx2 s[16:17], s[0:1], 56
    s_load_dwordx2 s[20:21], s[0:1], 16
    s_load_dwordx2 s[92:93], s[0:1], 0
    s_load_dwordx2 s[88:89], s[0:1], 64
    v_lshrrev_b32 v1, 6, v0
    v_and_b32 v8, 63, v0
    v_readfirstlane_b32 s23, v1
    v_lshlrev_b32 v9, 4, v8
    s_mov_b32 s6, 0xc00000
    s_mov_b32 s7, 0x20000
    s_and_b32 s25, s2, 7
    s_lshr_b32 s26, s2, 3
    s_and_b32 s27, s26, 3
    s_lshl_b32 s28, s25, 2
    s_add_u32 s27, s27, s28
    s_lshr_b32 s28, s26, 2
    s_mov_b32 s24, s23
    s_cmp_lt_u32 s23, 4
    s_cbranch_scc1 k2_side
    s_sub_u32 s24, s23, 4
    s_and_b32 s29, s24, 3
    s_lshr_b32 s30, s24, 2
    s_lshl_b32 s31, s28, 3
    s_lshl_b32 s32, s29, 1
    s_add_u32 s31, s31, s32
    s_add_u32 s31, s31, s30
    s_xor_b32 s32, s31, 1
    s_lshl_b32 s33, s27, 16
    s_lshl_b32 s34, s31, 10
    s_add_u32 s34, s34, s33
    s_lshl_b32 s35, s32, 10
    s_add_u32 s35, s35, s33
    s_lshr_b32 s36, s27, 1
    s_lshl_b32 s36, s36, 6
    s_and_b32 s37, s31, 0xfe
    s_add_u32 s36, s36, s37
    s_lshl_b32 s36, s36, 7
    s_add_u32 s36, s36, 0xa80000
    v_mov_b32 v2, 163776
    ds_read_b32 v3, v2
    s_mov_b32 s40, 0xffff
    s_mov_b32 s41, 0xffff
    s_lshl_b32 s42, s30, 11
    s_add_u32 s42, s42, 32768
    v_add_u32 v132, s42, v9
    v_mov_b64 v[48:49], 0
    v_mov_b64 v[64:65], 0
    v_mov_b64 v[50:51], 0
    v_mov_b64 v[66:67], 0
    v_mov_b64 v[52:53], 0
    v_mov_b64 v[68:69], 0
    v_mov_b64 v[54:55], 0
    v_mov_b64 v[70:71], 0
    v_mov_b64 v[56:57], 0
    v_mov_b64 v[72:73], 0
    v_mov_b64 v[58:59], 0
    v_mov_b64 v[74:75], 0
    v_mov_b64 v[60:61], 0
    v_mov_b64 v[76:77], 0
    v_mov_b64 v[62:63], 0
    v_mov_b64 v[78:79], 0
    v_and_b32 v4, 27, v8
    v_cmp_eq_u32 vcc, 16, v4
    v_mov_b32 v4, 0x3f803f80
    v_mov_b32 v136, 0xff61b1e6
    v_cndmask_b32 v124, 0, v4, vcc
    v_cndmask_b32 v125, 0, v4, vcc
    v_mov_b64 v[104:105], 0
    v_mov_b64 v[106:107], 0
    v_mov_b64 v[126:127], v[124:125]
    v_mov_b64 v[108:109], 0
    v_mov_b64 v[128:129], v[124:125]
    v_mov_b64 v[110:111], 0
    v_mov_b64 v[130:131], v[124:125]
    v_mov_b32 v137, 0xff61b1e6
    v_mov_b32 v80, 0xc2200000
    v_mov_b32 v81, 0xc2200000
    v_mov_b64 v[82:83], v[80:81]
    v_mov_b64 v[84:85], v[80:81]
    v_mov_b64 v[86:87], v[80:81]
    v_mov_b64 v[88:89], v[80:81]
    v_mov_b64 v[90:91], v[80:81]
    v_mov_b64 v[92:93], v[80:81]
    v_mov_b64 v[94:95], v[80:81]
    s_mul_i32 s45, s24, 2560
    s_add_u32 s45, s45, 12288
    s_xor_b32 s46, s24, 4
    s_mul_i32 s46, s46, 2560
    s_add_u32 s46, s46, 12288
    v_add_u32 v142, s45, v9
    v_add_u32 v143, s46, v9
    v_lshl_add_u32 v144, v8, 3, s45
    v_lshl_add_u32 v145, v8, 3, s46
    v_mov_b32 v149, 0
    v_lshl_add_u32 v146, s24, 2, 0
    v_xor_b32 v147, 16, v146
    s_lshl_b32 s47, s31, 15
    s_lshl_b32 s48, s27, 10
    s_add_u32 s47, s47, s48
    s_add_u32 s47, s47, 0x600000
    v_mov_b32 v148, 0
    v_mov_b32 v5, 0
    v_mov_b32 v7, 0
    v_and_b32 v2, 1, v8
    v_lshlrev_b32 v2, 7, v2
    s_cmp_eq_u32 s95, 0
    s_cbranch_scc1 k2_w0
    s_waitcnt vmcnt(2) lgkmcnt(0)
    s_branch k2_w
k2_w0:
    s_waitcnt vmcnt(0) lgkmcnt(0)
k2_w:
    v_readfirstlane_b32 s97, v3
    s_cmp_eq_u32 s96, 0
    s_cbranch_scc1 k2_noflag
    s_mov_b64 exec, 1
    buffer_store_dword v3, v7, s[4:7], s96 offen sc1
    s_mov_b64 exec, -1
k2_noflag:
    s_barrier
    s_mov_b32 s48, 0
k2_qp:
    buffer_load_dwordx4 v[112:115], v9, s[4:7], s34 offen sc1
    buffer_load_dwordx4 v[116:119], v9, s[4:7], s35 offen sc1
    s_add_u32 s48, s48, 1
    s_waitcnt vmcnt(0)
k2_qchk:
    v_max3_u32 v6, v112, v113, v114
    v_max3_u32 v6, v115, v116, v6
    v_max3_u32 v6, v117, v118, v6
    v_max_u32 v6, v119, v6
    v_cmp_eq_u32 vcc, -1, v6
    s_cmp_lt_u32 s48, 262144
    s_cselect_b64 vcc, vcc, 0
    s_cbranch_vccz k2_qok
    s_sleep 6
    s_branch k2_qp
k2_qok:
    s_mov_b32 s43, 0
    v_dot2c_f32_bf16 v148, v112, v112
    v_dot2c_f32_bf16 v5, v116, v116
    v_dot2c_f32_bf16 v148, v113, v113
    v_dot2c_f32_bf16 v5, v117, v117
    v_dot2c_f32_bf16 v148, v114, v114
    v_dot2c_f32_bf16 v5, v118, v118
    v_dot2c_f32_bf16 v148, v115, v115
    v_dot2c_f32_bf16 v5, v119, v119
    s_nop 2
    v_permlane32_swap_b32 v148, v5
    v_add_f32 v148, v148, v5
    s_barrier
    ds_read_b128 v[120:123], v132
    s_mov_b32 s44, 0
    s_waitcnt lgkmcnt(0)
    v_mfma_f32_32x32x16_bf16 v[16:31], v[120:123], v[112:115], v[80:95]
    s_nop 7
    s_branch k2_body
k2_loop:
    s_bitcmp1_b32 0x46, s44
    s_cbranch_scc1 k2_hook
k2_body:
    s_cmp_lg_u32 s43, 0
    s_cbranch_scc1 k2_slow
.p2align 3
    s_setprio 3
    v_mfma_f32_32x32x16_bf16 v[32:47], v[120:123], v[116:119], v[80:95]
    ds_read_b128 v[120:123], v132 offset:4096
    v_exp_f32 v16, v16
    v_exp_f32 v17, v17
    v_exp_f32 v18, v18
    v_exp_f32 v19, v19
    v_cvt_pk_bf16_f32 v96, v16, v17
    v_exp_f32 v20, v20
    v_exp_f32 v21, v21
    v_cvt_pk_bf16_f32 v97, v18, v19
    v_mfma_f32_32x32x16_bf16 v[64:79], v[124:127], v[104:107], v[64:79]
    v_exp_f32 v22, v22
    v_exp_f32 v23, v23
    v_cvt_pk_bf16_f32 v98, v20, v21
    v_exp_f32 v24, v24
    v_exp_f32 v25, v25
    v_cvt_pk_bf16_f32 v99, v22, v23
    v_exp_f32 v26, v26
    v_exp_f32 v27, v27
    v_mfma_f32_32x32x16_bf16 v[64:79], v[128:131], v[108:111], v[64:79]
    s_mov_b64 exec, s[40:41]
    ds_read_b128 v[124:127], v132 offset:1024
    ds_read_b128 v[128:131], v132 offset:1280
    s_mov_b64 exec, -1
    v_cvt_pk_bf16_f32 v100, v24, v25
    v_exp_f32 v28, v28
    v_exp_f32 v29, v29
    v_cvt_pk_bf16_f32 v101, v26, v27
    v_exp_f32 v30, v30
    v_exp_f32 v31, v31
    v_cvt_pk_bf16_f32 v102, v28, v29
    v_cvt_pk_bf16_f32 v103, v30, v31
    s_waitcnt lgkmcnt(2)
    v_mfma_f32_32x32x16_bf16 v[16:31], v[120:123], v[112:115], v[80:95]
    v_exp_f32 v32, v32
    v_exp_f32 v33, v33
    v_exp_f32 v34, v34
    v_exp_f32 v35, v35
    v_cvt_pk_bf16_f32 v104, v32, v33
    v_exp_f32 v36, v36
    v_exp_f32 v37, v37
    v_cvt_pk_bf16_f32 v105, v34, v35
    s_waitcnt lgkmcnt(0)
    v_mfma_f32_32x32x16_bf16 v[48:63], v[124:127], v[96:99], v[48:63]
    v_exp_f32 v38, v38
    v_exp_f32 v39, v39
    v_cvt_pk_bf16_f32 v106, v36, v37
    v_exp_f32 v40, v40
    v_exp_f32 v41, v41
    v_cvt_pk_bf16_f32 v107, v38, v39
    v_exp_f32 v42, v42
    v_exp_f32 v43, v43
    v_mfma_f32_32x32x16_bf16 v[48:63], v[128:131], v[100:103], v[48:63]
    v_cvt_pk_bf16_f32 v108, v40, v41
    v_exp_f32 v44, v44
    v_exp_f32 v45, v45
    v_cvt_pk_bf16_f32 v109, v42, v43
    v_exp_f32 v46, v46
    v_exp_f32 v47, v47
    v_cvt_pk_bf16_f32 v110, v44, v45
    v_cvt_pk_bf16_f32 v111, v46, v47
    s_setprio 2
    v_mfma_f32_32x32x16_bf16 v[32:47], v[120:123], v[116:119], v[80:95]
    ds_read_b128 v[120:123], v132 offset:8192
    v_exp_f32 v16, v16
    v_exp_f32 v17, v17
    v_exp_f32 v18, v18
    v_exp_f32 v19, v19
    v_cvt_pk_bf16_f32 v96, v16, v17
    v_exp_f32 v20, v20
    v_exp_f32 v21, v21
    v_cvt_pk_bf16_f32 v97, v18, v19
    v_mfma_f32_32x32x16_bf16 v[64:79], v[124:127], v[104:107], v[64:79]
    v_exp_f32 v22, v22
    v_exp_f32 v23, v23
    v_cvt_pk_bf16_f32 v98, v20, v21
    v_exp_f32 v24, v24
    v_exp_f32 v25, v25
    v_cvt_pk_bf16_f32 v99, v22, v23
    v_exp_f32 v26, v26
    v_exp_f32 v27, v27
    v_mfma_f32_32x32x16_bf16 v[64:79], v[128:131], v[108:111], v[64:79]
    s_mov_b64 exec, s[40:41]
    ds_read_b128 v[124:127], v132 offset:5120
    ds_read_b128 v[128:131], v132 offset:5376
    s_mov_b64 exec, -1
    v_cvt_pk_bf16_f32 v100, v24, v25
    v_exp_f32 v28, v28
    v_exp_f32 v29, v29
    v_cvt_pk_bf16_f32 v101, v26, v27
    v_exp_f32 v30, v30
    v_exp_f32 v31, v31
    v_cvt_pk_bf16_f32 v102, v28, v29
    v_cvt_pk_bf16_f32 v103, v30, v31
    s_waitcnt lgkmcnt(2)
    v_mfma_f32_32x32x16_bf16 v[16:31], v[120:123], v[112:115], v[80:95]
    v_exp_f32 v32, v32
    v_exp_f32 v33, v33
    v_exp_f32 v34, v34
    v_exp_f32 v35, v35
    v_cvt_pk_bf16_f32 v104, v32, v33
    v_exp_f32 v36, v36
    v_exp_f32 v37, v37
    v_cvt_pk_bf16_f32 v105, v34, v35
    s_waitcnt lgkmcnt(0)
    v_mfma_f32_32x32x16_bf16 v[48:63], v[124:127], v[96:99], v[48:63]
    v_exp_f32 v38, v38
    v_exp_f32 v39, v39
    v_cvt_pk_bf16_f32 v106, v36, v37
    v_exp_f32 v40, v40
    v_exp_f32 v41, v41
    v_cvt_pk_bf16_f32 v107, v38, v39
    v_exp_f32 v42, v42
    v_exp_f32 v43, v43
    v_mfma_f32_32x32x16_bf16 v[48:63], v[128:131], v[100:103], v[48:63]
    v_cvt_pk_bf16_f32 v108, v40, v41
    v_exp_f32 v44, v44
    v_exp_f32 v45, v45
    v_cvt_pk_bf16_f32 v109, v42, v43
    v_exp_f32 v46, v46
    v_exp_f32 v47, v47
    v_cvt_pk_bf16_f32 v110, v44, v45
    v_cvt_pk_bf16_f32 v111, v46, v47
    s_setprio 1
    v_mfma_f32_32x32x16_bf16 v[32:47], v[120:123], v[116:119], v[80:95]
    ds_read_b128 v[120:123], v132 offset:12288
    v_exp_f32 v16, v16
    v_exp_f32 v17, v17
    v_exp_f32 v18, v18
    v_exp_f32 v19, v19
    v_cvt_pk_bf16_f32 v96, v16, v17
    v_exp_f32 v20, v20
    v_exp_f32 v21, v21
    v_cvt_pk_bf16_f32 v97, v18, v19
    v_mfma_f32_32x32x16_bf16 v[64:79], v[124:127], v[104:107], v[64:79]
    v_exp_f32 v22, v22
    v_exp_f32 v23, v23
    v_cvt_pk_bf16_f32 v98, v20, v21
    v_exp_f32 v24, v24
    v_exp_f32 v25, v25
    v_cvt_pk_bf16_f32 v99, v22, v23
    v_exp_f32 v26, v26
    v_exp_f32 v27, v27
    v_mfma_f32_32x32x16_bf16 v[64:79], v[128:131], v[108:111], v[64:79]
    s_mov_b64 exec, s[40:41]
    ds_read_b128 v[124:127], v132 offset:9216
    ds_read_b128 v[128:131], v132 offset:9472
    s_mov_b64 exec, -1
    v_cvt_pk_bf16_f32 v100, v24, v25
    v_exp_f32 v28, v28
    v_exp_f32 v29, v29
    v_cvt_pk_bf16_f32 v101, v26, v27
    v_exp_f32 v30, v30
    v_exp_f32 v31, v31
    v_cvt_pk_bf16_f32 v102, v28, v29
    v_cvt_pk_bf16_f32 v103, v30, v31
    s_waitcnt lgkmcnt(2)
    v_mfma_f32_32x32x16_bf16 v[16:31], v[120:123], v[112:115], v[80:95]
    v_exp_f32 v32, v32
    v_exp_f32 v33, v33
    v_exp_f32 v34, v34
    v_exp_f32 v35, v35
    v_cvt_pk_bf16_f32 v104, v32, v33
    v_exp_f32 v36, v36
    v_exp_f32 v37, v37
    v_cvt_pk_bf16_f32 v105, v34, v35
    s_waitcnt lgkmcnt(0)
    v_mfma_f32_32x32x16_bf16 v[48:63], v[124:127], v[96:99], v[48:63]
    v_exp_f32 v38, v38
    v_exp_f32 v39, v39
    v_cvt_pk_bf16_f32 v106, v36, v37
    v_exp_f32 v40, v40
    v_exp_f32 v41, v41
    v_cvt_pk_bf16_f32 v107, v38, v39
    v_exp_f32 v42, v42
    v_exp_f32 v43, v43
    v_mfma_f32_32x32x16_bf16 v[48:63], v[128:131], v[100:103], v[48:63]
    v_cvt_pk_bf16_f32 v108, v40, v41
    v_exp_f32 v44, v44
    v_exp_f32 v45, v45
    v_cvt_pk_bf16_f32 v109, v42, v43
    v_exp_f32 v46, v46
    v_exp_f32 v47, v47
    v_cvt_pk_bf16_f32 v110, v44, v45
    v_cvt_pk_bf16_f32 v111, v46, v47
    s_setprio 0
    v_mfma_f32_32x32x16_bf16 v[32:47], v[120:123], v[116:119], v[80:95]
    ds_read_b128 v[120:123], v132 offset:16384
    v_exp_f32 v16, v16
    v_exp_f32 v17, v17
    v_exp_f32 v18, v18
    v_exp_f32 v19, v19
    v_cvt_pk_bf16_f32 v96, v16, v17
    v_exp_f32 v20, v20
    v_exp_f32 v21, v21
    v_cvt_pk_bf16_f32 v97, v18, v19
    v_mfma_f32_32x32x16_bf16 v[64:79], v[124:127], v[104:107], v[64:79]
    v_exp_f32 v22, v22
    v_exp_f32 v23, v23
    v_cvt_pk_bf16_f32 v98, v20, v21
    v_exp_f32 v24, v24
    v_exp_f32 v25, v25
    v_cvt_pk_bf16_f32 v99, v22, v23
    v_exp_f32 v26, v26
    v_exp_f32 v27, v27
    v_mfma_f32_32x32x16_bf16 v[64:79], v[128:131], v[108:111], v[64:79]
    s_mov_b64 exec, s[40:41]
    ds_read_b128 v[124:127], v132 offset:13312
    ds_read_b128 v[128:131], v132 offset:13568
    s_mov_b64 exec, -1
    v_cvt_pk_bf16_f32 v100, v24, v25
    v_exp_f32 v28, v28
    v_exp_f32 v29, v29
    v_cvt_pk_bf16_f32 v101, v26, v27
    v_exp_f32 v30, v30
    v_exp_f32 v31, v31
    v_cvt_pk_bf16_f32 v102, v28, v29
    v_cvt_pk_bf16_f32 v103, v30, v31
    s_waitcnt lgkmcnt(2)
    v_mfma_f32_32x32x16_bf16 v[16:31], v[120:123], v[112:115], v[80:95]
    v_exp_f32 v32, v32
    v_exp_f32 v33, v33
    v_exp_f32 v34, v34
    v_exp_f32 v35, v35
    v_cvt_pk_bf16_f32 v104, v32, v33
    v_exp_f32 v36, v36
    v_exp_f32 v37, v37
    v_cvt_pk_bf16_f32 v105, v34, v35
    s_waitcnt lgkmcnt(0)
    v_mfma_f32_32x32x16_bf16 v[48:63], v[124:127], v[96:99], v[48:63]
    v_exp_f32 v38, v38
    v_exp_f32 v39, v39
    v_cvt_pk_bf16_f32 v106, v36, v37
    v_exp_f32 v40, v40
    v_exp_f32 v41, v41
    v_cvt_pk_bf16_f32 v107, v38, v39
    v_exp_f32 v42, v42
    v_exp_f32 v43, v43
    v_mfma_f32_32x32x16_bf16 v[48:63], v[128:131], v[100:103], v[48:63]
    v_cvt_pk_bf16_f32 v108, v40, v41
    v_exp_f32 v44, v44
    v_exp_f32 v45, v45
    v_cvt_pk_bf16_f32 v109, v42, v43
    v_exp_f32 v46, v46
    v_exp_f32 v47, v47
    v_cvt_pk_bf16_f32 v110, v44, v45
    v_cvt_pk_bf16_f32 v111, v46, v47
    v_add_u32 v132, 0x4000, v132
k2_next:
    s_add_u32 s44, s44, 1
    s_cmp_lt_u32 s44, 8
    s_cbranch_scc1 k2_loop
    s_cmp_lg_u32 s43, 0
    s_cbranch_scc1 k2_nopv
    v_mfma_f32_32x32x16_bf16 v[64:79], v[124:127], v[104:107], v[64:79]
    v_mfma_f32_32x32x16_bf16 v[64:79], v[128:131], v[108:111], v[64:79]
k2_nopv:
    v_readfirstlane_b32 s48, v149
    s_cmp_ge_u32 s48, 5
    s_cbranch_scc1 k2_bfree
    v_mov_b32 v2, 0
k2_bwait:
    ds_read_b32 v3, v2 offset:0
    s_waitcnt lgkmcnt(0)
    v_readfirstlane_b32 s48, v3
    s_cmp_lt_u32 s48, 5
    s_cbranch_scc1 k2_bwait
k2_bfree:
    s_and_b32 s29, s24, 1
    s_lshr_b32 s30, s24, 1
    s_lshl_b32 s37, s27, 1
    s_add_u32 s37, s37, s29
    s_lshl_b32 s45, s37, 1
    s_add_u32 s45, s45, s30
    s_lshl_b32 s37, s45, 14
    s_add_u32 s37, s37, 0x600000
    s_lshl_b32 s40, s28, 11
    s_or_b32 s37, s37, s40
    v_lshlrev_b32 v4, 10, v8
    v_xor_b32 v4, s37, v4
    v_mov_b32 v2, -1
    s_mov_b32 s49, 0
    v_mov_b32 v73, v137
    ds_write_b128 v142, v[64:67]
    ds_write_b128 v142, v[68:71] offset:1024
    ds_write_b64 v144, v[72:73] offset:2048
    v_mov_b32 v3, 9
    ds_write_b32 v146, v3 offset:32
    s_branch k2_pg
k2_pw:
    s_sleep 3
    ds_read_b32 v3, v147 offset:32
    s_waitcnt lgkmcnt(0)
    v_readfirstlane_b32 s48, v3
    s_cmp_ge_u32 s48, 9
    s_cbranch_scc0 k2_pw
k2_pg:
    ds_read_b32 v3, v147 offset:32
    ds_read_b64 v[24:25], v145 offset:2048
    ds_read_b128 v[16:19], v143
    ds_read_b128 v[20:23], v143 offset:1024
    s_waitcnt lgkmcnt(3)
    v_readfirstlane_b32 s48, v3
    s_cmp_ge_u32 s48, 9
    s_cbranch_scc0 k2_pw
    s_cmp_lg_u32 s43, 0
    s_cbranch_scc1 k2_merge_slow
    s_waitcnt lgkmcnt(2)
k2_merged:
    v_add_f32 v56, v56, v24
    v_rcp_f32 v56, v56
    s_waitcnt lgkmcnt(0)
    v_add_f32 v48, v48, v16
    v_add_f32 v49, v49, v17
    v_add_f32 v50, v50, v18
    v_add_f32 v51, v51, v19
    v_add_f32 v52, v52, v20
    v_add_f32 v53, v53, v21
    v_add_f32 v54, v54, v22
    v_add_f32 v55, v55, v23
    v_mul_f32 v48, v48, v56
    v_mul_f32 v49, v49, v56
    v_mul_f32 v50, v50, v56
    v_mul_f32 v51, v51, v56
    v_mul_f32 v52, v52, v56
    v_mul_f32 v53, v53, v56
    v_mul_f32 v54, v54, v56
    v_mul_f32 v55, v55, v56
    v_cvt_pk_bf16_f32 v96, v48, v49
    v_cvt_pk_bf16_f32 v97, v50, v51
    v_cvt_pk_bf16_f32 v98, v52, v53
    v_cvt_pk_bf16_f32 v99, v54, v55
    v_min_u32 v96, -2, v96
    v_min_u32 v97, -2, v97
    v_min_u32 v98, -2, v98
    v_min_u32 v99, -2, v99
    buffer_store_dwordx4 v[96:99], v9, s[4:7], s47 offen sc1
    s_cmp_ge_u32 s24, 4
    s_cbranch_scc1 k2_done
    s_mov_b32 s46, 0xffff
    s_mov_b32 s48, 0
    s_mov_b32 s47, 0xa00000
    v_mov_b32 v5, 0
    v_lshrrev_b32 v3, 5, v8
    v_bfe_u32 v10, v8, 2, 2
    v_lshlrev_b32 v11, 9, v3
    v_lshl_add_u32 v11, v10, 7, v11
    v_and_b32 v12, 8, v8
    v_lshl_add_u32 v11, v12, 3, v11
    v_and_b32 v12, 16, v8
    v_lshl_add_u32 v11, v12, 1, v11
    v_and_b32 v12, 3, v8
    v_lshl_add_u32 v11, v12, 3, v11
    s_lshl_b32 s41, s30, 15
    s_lshl_b32 s42, s28, 12
    s_or_b32 s41, s41, s42
    s_add_u32 s41, s41, 65536
    v_add_u32 v11, s41, v11
    v_and_b32 v13, 31, v8
    v_lshl_add_u32 v13, s29, 5, v13
    v_and_b32 v12, 7, v8
    v_xor_b32 v12, v12, v3
    v_lshlrev_b32 v13, 8, v13
    v_lshl_add_u32 v13, v12, 4, v13
    s_lshl_b32 s43, s30, 14
    s_add_u32 s43, s43, 131072
    v_add_u32 v13, s43, v13
    v_mov_b64 v[80:81], 0
    v_mov_b64 v[82:83], 0
    v_mov_b64 v[84:85], 0
    v_mov_b64 v[86:87], 0
    v_mov_b64 v[88:89], 0
    v_mov_b64 v[90:91], 0
    v_mov_b64 v[92:93], 0
    v_mov_b64 v[94:95], 0
    v_mov_b64 v[96:97], 0
    v_mov_b64 v[98:99], 0
    v_mov_b64 v[100:101], 0
    v_mov_b64 v[102:103], 0
    v_mov_b64 v[104:105], 0
    v_mov_b64 v[106:107], 0
    v_mov_b64 v[108:109], 0
    v_mov_b64 v[110:111], 0
    v_mov_b32 v24, 0
k2_lw_13:
    ds_read_b128 v[16:19], v24 offset:16
    s_waitcnt lgkmcnt(0)
    v_min3_u32 v16, v16, v17, v18
    v_min_u32 v16, v16, v19
    s_nop 0
    v_readfirstlane_b32 s45, v16
    s_cmp_ge_u32 s45, 99
    s_cbranch_scc1 k2_lg_14
    s_sleep 2
    s_branch k2_lw_13
k2_lg_14:
    v_xor_b32 v6, 0, v11
    v_xor_b32 v7, 64, v11
    ds_read_b64_tr_b16 v[112:113], v6 offset:0
    ds_read_b64_tr_b16 v[114:115], v6 offset:1024
    ds_read_b64_tr_b16 v[116:117], v7 offset:0
    ds_read_b64_tr_b16 v[118:119], v7 offset:1024
    v_xor_b32 v6, 2048, v11
    v_xor_b32 v7, 2112, v11
    ds_read_b64_tr_b16 v[120:121], v6 offset:0
    ds_read_b64_tr_b16 v[122:123], v6 offset:1024
    ds_read_b64_tr_b16 v[124:125], v7 offset:0
    ds_read_b64_tr_b16 v[126:127], v7 offset:1024
    v_xor_b32 v6, 4096, v11
    v_xor_b32 v7, 4160, v11
    ds_read_b64_tr_b16 v[128:129], v6 offset:0
    ds_read_b64_tr_b16 v[130:131], v6 offset:1024
    ds_read_b64_tr_b16 v[132:133], v7 offset:0
    ds_read_b64_tr_b16 v[134:135], v7 offset:1024
    v_xor_b32 v6, 6144, v11
    v_xor_b32 v7, 6208, v11
    ds_read_b64_tr_b16 v[136:137], v6 offset:0
    ds_read_b64_tr_b16 v[138:139], v6 offset:1024
    ds_read_b64_tr_b16 v[140:141], v7 offset:0
    ds_read_b64_tr_b16 v[142:143], v7 offset:1024
    v_xor_b32 v6, 8192, v11
    v_xor_b32 v7, 8256, v11
    ds_read_b64_tr_b16 v[144:145], v6 offset:0
    ds_read_b64_tr_b16 v[146:147], v6 offset:1024
    ds_read_b64_tr_b16 v[148:149], v7 offset:0
    ds_read_b64_tr_b16 v[150:151], v7 offset:1024
    v_xor_b32 v6, 10240, v11
    v_xor_b32 v7, 10304, v11
    ds_read_b64_tr_b16 v[152:153], v6 offset:0
    ds_read_b64_tr_b16 v[154:155], v6 offset:1024
    ds_read_b64_tr_b16 v[156:157], v7 offset:0
    ds_read_b64_tr_b16 v[158:159], v7 offset:1024
    v_xor_b32 v6, 12288, v11
    v_xor_b32 v7, 12352, v11
    ds_read_b64_tr_b16 v[160:161], v6 offset:0
    ds_read_b64_tr_b16 v[162:163], v6 offset:1024
    ds_read_b64_tr_b16 v[164:165], v7 offset:0
    ds_read_b64_tr_b16 v[166:167], v7 offset:1024
    v_mov_b32 v24, 0
k2_lw_15:
    ds_read_b128 v[16:19], v24 offset:32
    ds_read_b128 v[20:23], v24 offset:48
    s_waitcnt lgkmcnt(0)
    v_min3_u32 v16, v16, v17, v18
    v_min3_u32 v16, v16, v19, v20
    v_min3_u32 v16, v16, v21, v22
    v_min_u32 v16, v16, v23
    s_nop 0
    v_readfirstlane_b32 s45, v16
    s_cmp_ge_u32 s45, 9
    s_cbranch_scc1 k2_lg_16
    s_sleep 2
    s_branch k2_lw_15
k2_lg_16:
    s_sleep 8
    s_mov_b64 exec, 0xffff
    buffer_load_dword v2, v4, s[4:7], 0 offen offset:1020 sc1
    s_mov_b64 exec, -1
k2_round:
    s_waitcnt vmcnt(0)
    v_cmp_eq_u32 vcc, -1, v2
    s_and_b32 s45, vcc_lo, 0xffff
    s_cbranch_scc0 k2_fetch
    s_mov_b64 exec, 0xffff
    buffer_load_dword v2, v4, s[4:7], 0 offen offset:1020 sc1
    s_mov_b64 exec, -1
    s_add_u32 s48, s48, 1
    s_cmp_lt_u32 s48, 262144
    s_cbranch_scc1 k2_round
k2_fetch:
    s_xor_b32 s41, s37, 0
    buffer_load_dwordx4 v[16:19], v9, s[4:7], s41 offen sc1
    s_xor_b32 s41, s37, 1024
    buffer_load_dwordx4 v[20:23], v9, s[4:7], s41 offen sc1
    s_xor_b32 s41, s37, 2048
    buffer_load_dwordx4 v[24:27], v9, s[4:7], s41 offen sc1
    s_xor_b32 s41, s37, 3072
    buffer_load_dwordx4 v[28:31], v9, s[4:7], s41 offen sc1
    s_xor_b32 s41, s37, 4096
    buffer_load_dwordx4 v[32:35], v9, s[4:7], s41 offen sc1
    s_xor_b32 s41, s37, 5120
    buffer_load_dwordx4 v[36:39], v9, s[4:7], s41 offen sc1
    s_xor_b32 s41, s37, 6144
    buffer_load_dwordx4 v[40:43], v9, s[4:7], s41 offen sc1
    s_xor_b32 s41, s37, 7168
    buffer_load_dwordx4 v[44:47], v9, s[4:7], s41 offen sc1
    s_xor_b32 s41, s37, 8192
    buffer_load_dwordx4 v[48:51], v9, s[4:7], s41 offen sc1
    s_xor_b32 s41, s37, 9216
    buffer_load_dwordx4 v[52:55], v9, s[4:7], s41 offen sc1
    s_xor_b32 s41, s37, 10240
    buffer_load_dwordx4 v[56:59], v9, s[4:7], s41 offen sc1
    s_xor_b32 s41, s37, 11264
    buffer_load_dwordx4 v[60:63], v9, s[4:7], s41 offen sc1
    s_xor_b32 s41, s37, 12288
    buffer_load_dwordx4 v[64:67], v9, s[4:7], s41 offen sc1
    s_xor_b32 s41, s37, 13312
    buffer_load_dwordx4 v[68:71], v9, s[4:7], s41 offen sc1
    s_xor_b32 s41, s37, 14336
    buffer_load_dwordx4 v[72:75], v9, s[4:7], s41 offen sc1
    s_xor_b32 s41, s37, 15360
    buffer_load_dwordx4 v[76:79], v9, s[4:7], s41 offen sc1
    s_waitcnt vmcnt(15) lgkmcnt(15)
    v_mfma_f32_32x32x16_bf16 v[80:95], v[112:115], v[16:19], 0
    v_max3_u32 v5, v16, v17, 0
    v_mfma_f32_32x32x16_bf16 v[96:111], v[116:119], v[16:19], 0
    v_max3_u32 v5, v18, v19, v5
    v_xor_b32 v6, 14336, v11
    v_xor_b32 v7, 14400, v11
    ds_read_b64_tr_b16 v[112:113], v6 offset:0
    ds_read_b64_tr_b16 v[114:115], v6 offset:1024
    ds_read_b64_tr_b16 v[116:117], v7 offset:0
    ds_read_b64_tr_b16 v[118:119], v7 offset:1024
    s_waitcnt vmcnt(14) lgkmcnt(15)
    v_mfma_f32_32x32x16_bf16 v[80:95], v[120:123], v[20:23], v[80:95]
    v_max3_u32 v5, v20, v21, v5
    v_mfma_f32_32x32x16_bf16 v[96:111], v[124:127], v[20:23], v[96:111]
    v_max3_u32 v5, v22, v23, v5
    v_xor_b32 v6, 16384, v11
    v_xor_b32 v7, 16448, v11
    ds_read_b64_tr_b16 v[120:121], v6 offset:0
    ds_read_b64_tr_b16 v[122:123], v6 offset:1024
    ds_read_b64_tr_b16 v[124:125], v7 offset:0
    ds_read_b64_tr_b16 v[126:127], v7 offset:1024
    s_waitcnt vmcnt(13) lgkmcnt(15)
    v_mfma_f32_32x32x16_bf16 v[80:95], v[128:131], v[24:27], v[80:95]
    v_max3_u32 v5, v24, v25, v5
    v_mfma_f32_32x32x16_bf16 v[96:111], v[132:135], v[24:27], v[96:111]
    v_max3_u32 v5, v26, v27, v5
    v_xor_b32 v6, 18432, v11
    v_xor_b32 v7, 18496, v11
    ds_read_b64_tr_b16 v[128:129], v6 offset:0
    ds_read_b64_tr_b16 v[130:131], v6 offset:1024
    ds_read_b64_tr_b16 v[132:133], v7 offset:0
    ds_read_b64_tr_b16 v[134:135], v7 offset:1024
    s_waitcnt vmcnt(12) lgkmcnt(15)
    v_mfma_f32_32x32x16_bf16 v[80:95], v[136:139], v[28:31], v[80:95]
    v_max3_u32 v5, v28, v29, v5
    v_mfma_f32_32x32x16_bf16 v[96:111], v[140:143], v[28:31], v[96:111]
    v_max3_u32 v5, v30, v31, v5
    v_xor_b32 v6, 20480, v11
    v_xor_b32 v7, 20544, v11
    ds_read_b64_tr_b16 v[136:137], v6 offset:0
    ds_read_b64_tr_b16 v[138:139], v6 offset:1024
    ds_read_b64_tr_b16 v[140:141], v7 offset:0
    ds_read_b64_tr_b16 v[142:143], v7 offset:1024
    s_waitcnt vmcnt(11) lgkmcnt(15)
    v_mfma_f32_32x32x16_bf16 v[80:95], v[144:147], v[32:35], v[80:95]
    v_max3_u32 v5, v32, v33, v5
    v_mfma_f32_32x32x16_bf16 v[96:111], v[148:151], v[32:35], v[96:111]
    v_max3_u32 v5, v34, v35, v5
    v_xor_b32 v6, 22528, v11
    v_xor_b32 v7, 22592, v11
    ds_read_b64_tr_b16 v[144:145], v6 offset:0
    ds_read_b64_tr_b16 v[146:147], v6 offset:1024
    ds_read_b64_tr_b16 v[148:149], v7 offset:0
    ds_read_b64_tr_b16 v[150:151], v7 offset:1024
    s_waitcnt vmcnt(10) lgkmcnt(15)
    v_mfma_f32_32x32x16_bf16 v[80:95], v[152:155], v[36:39], v[80:95]
    v_max3_u32 v5, v36, v37, v5
    v_mfma_f32_32x32x16_bf16 v[96:111], v[156:159], v[36:39], v[96:111]
    v_max3_u32 v5, v38, v39, v5
    v_xor_b32 v6, 24576, v11
    v_xor_b32 v7, 24640, v11
    ds_read_b64_tr_b16 v[152:153], v6 offset:0
    ds_read_b64_tr_b16 v[154:155], v6 offset:1024
    ds_read_b64_tr_b16 v[156:157], v7 offset:0
    ds_read_b64_tr_b16 v[158:159], v7 offset:1024
    s_waitcnt vmcnt(9) lgkmcnt(15)
    v_mfma_f32_32x32x16_bf16 v[80:95], v[160:163], v[40:43], v[80:95]
    v_max3_u32 v5, v40, v41, v5
    v_mfma_f32_32x32x16_bf16 v[96:111], v[164:167], v[40:43], v[96:111]
    v_max3_u32 v5, v42, v43, v5
    v_xor_b32 v6, 26624, v11
    v_xor_b32 v7, 26688, v11
    ds_read_b64_tr_b16 v[160:161], v6 offset:0
    ds_read_b64_tr_b16 v[162:163], v6 offset:1024
    ds_read_b64_tr_b16 v[164:165], v7 offset:0
    ds_read_b64_tr_b16 v[166:167], v7 offset:1024
    s_waitcnt vmcnt(8) lgkmcnt(15)
    v_mfma_f32_32x32x16_bf16 v[80:95], v[112:115], v[44:47], v[80:95]
    v_max3_u32 v5, v44, v45, v5
    v_mfma_f32_32x32x16_bf16 v[96:111], v[116:119], v[44:47], v[96:111]
    v_max3_u32 v5, v46, v47, v5
    v_xor_b32 v6, 28672, v11
    v_xor_b32 v7, 28736, v11
    ds_read_b64_tr_b16 v[112:113], v6 offset:0
    ds_read_b64_tr_b16 v[114:115], v6 offset:1024
    ds_read_b64_tr_b16 v[116:117], v7 offset:0
    ds_read_b64_tr_b16 v[118:119], v7 offset:1024
    s_waitcnt vmcnt(7) lgkmcnt(15)
    v_mfma_f32_32x32x16_bf16 v[80:95], v[120:123], v[48:51], v[80:95]
    v_max3_u32 v5, v48, v49, v5
    v_mfma_f32_32x32x16_bf16 v[96:111], v[124:127], v[48:51], v[96:111]
    v_max3_u32 v5, v50, v51, v5
    v_xor_b32 v6, 30720, v11
    v_xor_b32 v7, 30784, v11
    ds_read_b64_tr_b16 v[120:121], v6 offset:0
    ds_read_b64_tr_b16 v[122:123], v6 offset:1024
    ds_read_b64_tr_b16 v[124:125], v7 offset:0
    ds_read_b64_tr_b16 v[126:127], v7 offset:1024
    s_waitcnt vmcnt(6) lgkmcnt(15)
    v_mfma_f32_32x32x16_bf16 v[80:95], v[128:131], v[52:55], v[80:95]
    v_max3_u32 v5, v52, v53, v5
    v_mfma_f32_32x32x16_bf16 v[96:111], v[132:135], v[52:55], v[96:111]
    v_max3_u32 v5, v54, v55, v5
    s_waitcnt vmcnt(5) lgkmcnt(15)
    v_mfma_f32_32x32x16_bf16 v[80:95], v[136:139], v[56:59], v[80:95]
    v_max3_u32 v5, v56, v57, v5
    v_mfma_f32_32x32x16_bf16 v[96:111], v[140:143], v[56:59], v[96:111]
    v_max3_u32 v5, v58, v59, v5
    s_waitcnt vmcnt(4) lgkmcnt(15)
    v_mfma_f32_32x32x16_bf16 v[80:95], v[144:147], v[60:63], v[80:95]
    v_max3_u32 v5, v60, v61, v5
    v_mfma_f32_32x32x16_bf16 v[96:111], v[148:151], v[60:63], v[96:111]
    v_max3_u32 v5, v62, v63, v5
    s_waitcnt vmcnt(3) lgkmcnt(12)
    v_mfma_f32_32x32x16_bf16 v[80:95], v[152:155], v[64:67], v[80:95]
    v_max3_u32 v5, v64, v65, v5
    v_mfma_f32_32x32x16_bf16 v[96:111], v[156:159], v[64:67], v[96:111]
    v_max3_u32 v5, v66, v67, v5
    s_waitcnt vmcnt(2) lgkmcnt(8)
    v_mfma_f32_32x32x16_bf16 v[80:95], v[160:163], v[68:71], v[80:95]
    v_max3_u32 v5, v68, v69, v5
    v_mfma_f32_32x32x16_bf16 v[96:111], v[164:167], v[68:71], v[96:111]
    v_max3_u32 v5, v70, v71, v5
    s_waitcnt vmcnt(1) lgkmcnt(4)
    v_mfma_f32_32x32x16_bf16 v[80:95], v[112:115], v[72:75], v[80:95]
    v_max3_u32 v5, v72, v73, v5
    v_mfma_f32_32x32x16_bf16 v[96:111], v[116:119], v[72:75], v[96:111]
    v_max3_u32 v5, v74, v75, v5
    s_waitcnt vmcnt(0) lgkmcnt(0)
    v_mfma_f32_32x32x16_bf16 v[80:95], v[120:123], v[76:79], v[80:95]
    v_max3_u32 v5, v76, v77, v5
    v_mfma_f32_32x32x16_bf16 v[96:111], v[124:127], v[76:79], v[96:111]
    v_max3_u32 v5, v78, v79, v5
    v_cmp_eq_u32 vcc, -1, v5
    s_cbranch_vccz k2_fok
    buffer_inv sc1
    s_mov_b32 s46, 0xffff
    v_mov_b32 v5, 0
    s_nop 7
    v_mov_b64 v[80:81], 0
    v_mov_b64 v[82:83], 0
    v_mov_b64 v[84:85], 0
    v_mov_b64 v[86:87], 0
    v_mov_b64 v[88:89], 0
    v_mov_b64 v[90:91], 0
    v_mov_b64 v[92:93], 0
    v_mov_b64 v[94:95], 0
    v_mov_b64 v[96:97], 0
    v_mov_b64 v[98:99], 0
    v_mov_b64 v[100:101], 0
    v_mov_b64 v[102:103], 0
    v_mov_b64 v[104:105], 0
    v_mov_b64 v[106:107], 0
    v_mov_b64 v[108:109], 0
    v_mov_b64 v[110:111], 0
    v_xor_b32 v6, 0, v11
    v_xor_b32 v7, 64, v11
    ds_read_b64_tr_b16 v[112:113], v6 offset:0
    ds_read_b64_tr_b16 v[114:115], v6 offset:1024
    ds_read_b64_tr_b16 v[116:117], v7 offset:0
    ds_read_b64_tr_b16 v[118:119], v7 offset:1024
    v_xor_b32 v6, 2048, v11
    v_xor_b32 v7, 2112, v11
    ds_read_b64_tr_b16 v[120:121], v6 offset:0
    ds_read_b64_tr_b16 v[122:123], v6 offset:1024
    ds_read_b64_tr_b16 v[124:125], v7 offset:0
    ds_read_b64_tr_b16 v[126:127], v7 offset:1024
    v_xor_b32 v6, 4096, v11
    v_xor_b32 v7, 4160, v11
    ds_read_b64_tr_b16 v[128:129], v6 offset:0
    ds_read_b64_tr_b16 v[130:131], v6 offset:1024
    ds_read_b64_tr_b16 v[132:133], v7 offset:0
    ds_read_b64_tr_b16 v[134:135], v7 offset:1024
    v_xor_b32 v6, 6144, v11
    v_xor_b32 v7, 6208, v11
    ds_read_b64_tr_b16 v[136:137], v6 offset:0
    ds_read_b64_tr_b16 v[138:139], v6 offset:1024
    ds_read_b64_tr_b16 v[140:141], v7 offset:0
    ds_read_b64_tr_b16 v[142:143], v7 offset:1024
    v_xor_b32 v6, 8192, v11
    v_xor_b32 v7, 8256, v11
    ds_read_b64_tr_b16 v[144:145], v6 offset:0
    ds_read_b64_tr_b16 v[146:147], v6 offset:1024
    ds_read_b64_tr_b16 v[148:149], v7 offset:0
    ds_read_b64_tr_b16 v[150:151], v7 offset:1024
    v_xor_b32 v6, 10240, v11
    v_xor_b32 v7, 10304, v11
    ds_read_b64_tr_b16 v[152:153], v6 offset:0
    ds_read_b64_tr_b16 v[154:155], v6 offset:1024
    ds_read_b64_tr_b16 v[156:157], v7 offset:0
    ds_read_b64_tr_b16 v[158:159], v7 offset:1024
    v_xor_b32 v6, 12288, v11
    v_xor_b32 v7, 12352, v11
    ds_read_b64_tr_b16 v[160:161], v6 offset:0
    ds_read_b64_tr_b16 v[162:163], v6 offset:1024
    ds_read_b64_tr_b16 v[164:165], v7 offset:0
    ds_read_b64_tr_b16 v[166:167], v7 offset:1024
    s_add_u32 s48, s48, 1
    s_cmp_lt_u32 s48, 262144
    s_cbranch_scc0 k2_fok
    s_waitcnt vmcnt(0)
    s_branch k2_fetch
    s_branch k2_round
k2_fok:
    v_xor_b32 v14, 32, v13
    v_xor_b32 v15, 64, v13
    v_xor_b32 v12, 96, v13
    s_nop 7
    ds_write_b128 v13, v[80:83] offset:0
    ds_write_b128 v14, v[84:87] offset:0
    ds_write_b128 v15, v[88:91] offset:0
    ds_write_b128 v12, v[92:95] offset:0
    ds_write_b128 v13, v[96:99] offset:128
    ds_write_b128 v14, v[100:103] offset:128
    ds_write_b128 v15, v[104:107] offset:128
    ds_write_b128 v12, v[108:111] offset:128
    s_waitcnt lgkmcnt(0)
    s_barrier
    s_endpgm
k2_done:
    v_and_b32 v2, 7, v8
    v_lshrrev_b32 v6, 3, v8
    v_lshlrev_b32 v5, 4, v2
    v_lshl_add_u32 v118, v6, 10, v5
    v_lshlrev_b32 v2, 2, v2
    ds_read_b32 v123, v2 offset:64
    s_waitcnt lgkmcnt(0)
    s_branch k2_tail
k2_end:
    s_endpgm
k2_merge_slow:
    s_waitcnt lgkmcnt(0)
    v_max_f32 v6, v136, v25
    v_sub_f32 v7, v136, v6
    v_sub_f32 v10, v25, v6
    v_exp_f32 v7, v7
    v_exp_f32 v10, v10
    v_mul_f32 v48, v48, v7
    v_mul_f32 v16, v16, v10
    v_mul_f32 v49, v49, v7
    v_mul_f32 v17, v17, v10
    v_mul_f32 v50, v50, v7
    v_mul_f32 v18, v18, v10
    v_mul_f32 v51, v51, v7
    v_mul_f32 v19, v19, v10
    v_mul_f32 v52, v52, v7
    v_mul_f32 v20, v20, v10
    v_mul_f32 v53, v53, v7
    v_mul_f32 v21, v21, v10
    v_mul_f32 v54, v54, v7
    v_mul_f32 v22, v22, v10
    v_mul_f32 v55, v55, v7
    v_mul_f32 v23, v23, v10
    v_mul_f32 v56, v56, v7
    v_mul_f32 v24, v24, v10
    s_branch k2_merged
k2_slow:
    s_mov_b32 s45, 0
k2_slow_tile:
    ds_read_b128 v[120:123], v132
    s_mov_b64 exec, s[40:41]
    ds_read_b128 v[124:127], v132 offset:1024
    ds_read_b128 v[128:131], v132 offset:1280
    s_mov_b64 exec, -1
    s_waitcnt lgkmcnt(0)
    v_mfma_f32_32x32x16_bf16 v[16:31], v[120:123], v[112:115], 0
    s_nop 11
    v_max3_f32 v138, v16, v17, v136
    v_max3_f32 v138, v18, v19, v138
    v_max3_f32 v138, v20, v21, v138
    v_max3_f32 v138, v22, v23, v138
    v_max3_f32 v138, v24, v25, v138
    v_max3_f32 v138, v26, v27, v138
    v_max3_f32 v138, v28, v29, v138
    v_max3_f32 v138, v30, v31, v138
    v_mov_b32 v139, v138
    s_nop 1
    v_permlane32_swap_b32 v138, v139
    v_max_f32 v138, v138, v139
    v_sub_f32 v139, v136, v138
    v_exp_f32 v139, v139
    v_mov_b32 v136, v138
    v_sub_f32 v16, v16, v138
    v_sub_f32 v17, v17, v138
    v_sub_f32 v18, v18, v138
    v_sub_f32 v19, v19, v138
    v_sub_f32 v20, v20, v138
    v_sub_f32 v21, v21, v138
    v_sub_f32 v22, v22, v138
    v_sub_f32 v23, v23, v138
    v_sub_f32 v24, v24, v138
    v_sub_f32 v25, v25, v138
    v_sub_f32 v26, v26, v138
    v_sub_f32 v27, v27, v138
    v_sub_f32 v28, v28, v138
    v_sub_f32 v29, v29, v138
    v_sub_f32 v30, v30, v138
    v_sub_f32 v31, v31, v138
    v_mul_f32 v48, v48, v139
    v_mul_f32 v49, v49, v139
    v_mul_f32 v50, v50, v139
    v_mul_f32 v51, v51, v139
    v_mul_f32 v52, v52, v139
    v_mul_f32 v53, v53, v139
    v_mul_f32 v54, v54, v139
    v_mul_f32 v55, v55, v139
    v_mul_f32 v56, v56, v139
    v_mul_f32 v57, v57, v139
    v_mul_f32 v58, v58, v139
    v_mul_f32 v59, v59, v139
    v_mul_f32 v60, v60, v139
    v_mul_f32 v61, v61, v139
    v_mul_f32 v62, v62, v139
    v_mul_f32 v63, v63, v139
    v_exp_f32 v16, v16
    v_exp_f32 v17, v17
    v_exp_f32 v18, v18
    v_exp_f32 v19, v19
    v_exp_f32 v20, v20
    v_exp_f32 v21, v21
    v_exp_f32 v22, v22
    v_exp_f32 v23, v23
    v_exp_f32 v24, v24
    v_exp_f32 v25, v25
    v_exp_f32 v26, v26
    v_exp_f32 v27, v27
    v_exp_f32 v28, v28
    v_exp_f32 v29, v29
    v_exp_f32 v30, v30
    v_exp_f32 v31, v31
    v_cvt_pk_bf16_f32 v96, v16, v17
    v_cvt_pk_bf16_f32 v97, v18, v19
    v_cvt_pk_bf16_f32 v98, v20, v21
    v_cvt_pk_bf16_f32 v99, v22, v23
    v_cvt_pk_bf16_f32 v100, v24, v25
    v_cvt_pk_bf16_f32 v101, v26, v27
    v_cvt_pk_bf16_f32 v102, v28, v29
    v_cvt_pk_bf16_f32 v103, v30, v31
    v_mfma_f32_32x32x16_bf16 v[48:63], v[124:127], v[96:99], v[48:63]
    s_nop 0
    v_mfma_f32_32x32x16_bf16 v[48:63], v[128:131], v[100:103], v[48:63]
    v_mfma_f32_32x32x16_bf16 v[32:47], v[120:123], v[116:119], 0
    s_nop 11
    v_max3_f32 v138, v32, v33, v137
    v_max3_f32 v138, v34, v35, v138
    v_max3_f32 v138, v36, v37, v138
    v_max3_f32 v138, v38, v39, v138
    v_max3_f32 v138, v40, v41, v138
    v_max3_f32 v138, v42, v43, v138
    v_max3_f32 v138, v44, v45, v138
    v_max3_f32 v138, v46, v47, v138
    v_mov_b32 v139, v138
    s_nop 1
    v_permlane32_swap_b32 v138, v139
    v_max_f32 v138, v138, v139
    v_sub_f32 v139, v137, v138
    v_exp_f32 v139, v139
    v_mov_b32 v137, v138
    v_sub_f32 v32, v32, v138
    v_sub_f32 v33, v33, v138
    v_sub_f32 v34, v34, v138
    v_sub_f32 v35, v35, v138
    v_sub_f32 v36, v36, v138
    v_sub_f32 v37, v37, v138
    v_sub_f32 v38, v38, v138
    v_sub_f32 v39, v39, v138
    v_sub_f32 v40, v40, v138
    v_sub_f32 v41, v41, v138
    v_sub_f32 v42, v42, v138
    v_sub_f32 v43, v43, v138
    v_sub_f32 v44, v44, v138
    v_sub_f32 v45, v45, v138
    v_sub_f32 v46, v46, v138
    v_sub_f32 v47, v47, v138
    v_mul_f32 v64, v64, v139
    v_mul_f32 v65, v65, v139
    v_mul_f32 v66, v66, v139
    v_mul_f32 v67, v67, v139
    v_mul_f32 v68, v68, v139
    v_mul_f32 v69, v69, v139
    v_mul_f32 v70, v70, v139
    v_mul_f32 v71, v71, v139
    v_mul_f32 v72, v72, v139
    v_mul_f32 v73, v73, v139
    v_mul_f32 v74, v74, v139
    v_mul_f32 v75, v75, v139
    v_mul_f32 v76, v76, v139
    v_mul_f32 v77, v77, v139
    v_mul_f32 v78, v78, v139
    v_mul_f32 v79, v79, v139
    v_exp_f32 v32, v32
    v_exp_f32 v33, v33
    v_exp_f32 v34, v34
    v_exp_f32 v35, v35
    v_exp_f32 v36, v36
    v_exp_f32 v37, v37
    v_exp_f32 v38, v38
    v_exp_f32 v39, v39
    v_exp_f32 v40, v40
    v_exp_f32 v41, v41
    v_exp_f32 v42, v42
    v_exp_f32 v43, v43
    v_exp_f32 v44, v44
    v_exp_f32 v45, v45
    v_exp_f32 v46, v46
    v_exp_f32 v47, v47
    v_cvt_pk_bf16_f32 v104, v32, v33
    v_cvt_pk_bf16_f32 v105, v34, v35
    v_cvt_pk_bf16_f32 v106, v36, v37
    v_cvt_pk_bf16_f32 v107, v38, v39
    v_cvt_pk_bf16_f32 v108, v40, v41
    v_cvt_pk_bf16_f32 v109, v42, v43
    v_cvt_pk_bf16_f32 v110, v44, v45
    v_cvt_pk_bf16_f32 v111, v46, v47
    v_mfma_f32_32x32x16_bf16 v[64:79], v[124:127], v[104:107], v[64:79]
    s_nop 0
    v_mfma_f32_32x32x16_bf16 v[64:79], v[128:131], v[108:111], v[64:79]
    v_add_u32 v132, 0x1000, v132
    s_add_u32 s45, s45, 1
    s_cmp_lt_u32 s45, 4
    s_cbranch_scc1 k2_slow_tile
    s_nop 7
    s_nop 7
    s_branch k2_next
k2_hook:
    s_cmp_eq_u32 s44, 1
    s_cbranch_scc0 k2_hook26
    v_mov_b32 v2, 0
k2_lw_17:
    ds_read_b128 v[4:7], v2 offset:16
    s_waitcnt lgkmcnt(0)
    v_min3_u32 v4, v4, v5, v6
    v_min_u32 v4, v4, v7
    s_nop 0
    v_readfirstlane_b32 s45, v4
    s_cmp_ge_u32 s45, 5
    s_cbranch_scc1 k2_lg_18
    s_sleep 1
    s_branch k2_lw_17
k2_lg_18:
    s_branch k2_body
k2_hook26:
    s_cmp_eq_u32 s44, 2
    s_cbranch_scc0 k2_hookp
    v_mov_b32 v2, 0
k2_lw_19:
    ds_read_b128 v[4:7], v2 offset:16
    s_waitcnt lgkmcnt(0)
    v_min3_u32 v4, v4, v5, v6
    v_min_u32 v4, v4, v7
    s_nop 0
    v_readfirstlane_b32 s45, v4
    s_cmp_ge_u32 s45, 16
    s_cbranch_scc1 k2_lg_20
    s_sleep 1
    s_branch k2_lw_19
k2_lg_20:
    ds_read_b32 v4, v2 offset:4
    s_cmp_lg_u32 s43, 0
    s_waitcnt lgkmcnt(0)
    s_cbranch_scc1 k2_hookp
    v_mul_f32 v4, v4, v148
    v_cmp_nge_f32 vcc, 0x44c03bd7, v4
    s_cbranch_vccz k2_hookp
    s_mov_b32 s43, 1
    s_mov_b32 s44, 0
    v_subrev_u32 v132, 0x8000, v132
    s_nop 7
    v_mov_b64 v[48:49], 0
    v_mov_b64 v[64:65], 0
    v_mov_b64 v[50:51], 0
    v_mov_b64 v[66:67], 0
    v_mov_b64 v[52:53], 0
    v_mov_b64 v[68:69], 0
    v_mov_b64 v[54:55], 0
    v_mov_b64 v[70:71], 0
    v_mov_b64 v[56:57], 0
    v_mov_b64 v[72:73], 0
    v_mov_b64 v[58:59], 0
    v_mov_b64 v[74:75], 0
    v_mov_b64 v[60:61], 0
    v_mov_b64 v[76:77], 0
    v_mov_b64 v[62:63], 0
    v_mov_b64 v[78:79], 0
    s_branch k2_body
k2_hookp:
    v_mov_b32 v3, s44
    v_mov_b32 v2, 0
    ds_write_b32 v146, v3 offset:32
    ds_read_b32 v149, v2 offset:0
    s_branch k2_body
k2_side:
    s_setprio 3
    s_lshl_b32 s38, s27, 17
    s_lshl_b32 s39, s24, 11
    s_add_u32 s38, s38, s39
    s_add_u32 s38, s38, 0x200000
    s_add_u32 s39, s39, 32768
    s_lshr_b32 s46, s27, 2
    s_lshl_b32 s46, s46, 13
    s_mov_b32 s45, 0x10000
    s_lshl_b32 s47, s24, 7
    s_add_u32 s46, s46, s47
    s_add_u32 s37, s46, 0xa40000
    v_and_b32 v4, 15, v8
    v_lshlrev_b32 v4, 9, v4
    v_bfe_u32 v5, v8, 4, 1
    v_mad_u32_u24 v4, v5, s45, v4
    v_mov_b32 v2, 163776
    ds_read_b128 v[12:15], v2 offset:16
    ds_read_b128 v[20:23], v2 offset:32
    s_waitcnt lgkmcnt(0)
    v_readfirstlane_b32 s56, v12
    v_readfirstlane_b32 s60, v20
    v_readfirstlane_b32 s57, v13
    v_readfirstlane_b32 s61, v21
    v_readfirstlane_b32 s58, v14
    v_readfirstlane_b32 s62, v22
    v_readfirstlane_b32 s59, v15
    v_readfirstlane_b32 s63, v23
    s_mov_b32 s12, s10
    s_mov_b32 s13, s11
    s_mov_b32 s10, 1835008
    s_mov_b32 s11, 0x20000
    s_mov_b32 s14, 1835008
    s_mov_b32 s15, 0x20000
    s_mov_b32 s18, 1835008
    s_mov_b32 s19, 0x20000
    s_mov_b32 s34, 0x80000
    s_mov_b32 s35, 0x20000
    v_and_b32 v117, 7, v8
    v_lshrrev_b32 v6, 3, v8
    v_lshlrev_b32 v5, 4, v117
    v_lshl_add_u32 v118, v6, 10, v5
    v_lshlrev_b32 v117, 2, v117
    s_mov_b32 s40, 0xffff
    s_mov_b32 s41, 0
    s_mov_b32 s48, 0
    s_mov_b32 s45, 0xa18000
    s_branch k2_mkc
k2_mk:
    buffer_load_dword v116, v119, s[4:7], s45 offen offset:4 sc1
k2_mkc:
    s_add_u32 s48, s48, 1
    s_waitcnt vmcnt(0)
    v_cmp_ne_u32 vcc, s97, v116
    s_cmp_lt_u32 s48, 262144
    s_cselect_b64 vcc, vcc, 0
    s_cbranch_vccnz k2_mk
    s_mov_b32 s48, 0
    s_waitcnt vmcnt(0)
    s_barrier
    v_mov_b32 v5, 0
    v_lshlrev_b32 v2, 2, v8
    v_and_b32 v2, 124, v2
    ds_write_b32 v2, v5
    s_sleep 1
    v_add_u32 v10, s39, v9
k2_first:
    s_add_u32 m0, s39, 0
    s_add_u32 s46, s38, 0
    buffer_load_dwordx4 v9, s[4:7], s46 offen sc1 lds
    s_add_u32 m0, s39, 1024
    s_add_u32 s46, s38, 1024
    buffer_load_dwordx4 v9, s[4:7], s46 offen sc1 lds
    s_add_u32 m0, s39, 8192
    s_add_u32 s46, s38, 8192
    buffer_load_dwordx4 v9, s[4:7], s46 offen sc1 lds
    s_add_u32 m0, s39, 9216
    s_add_u32 s46, s38, 9216
    buffer_load_dwordx4 v9, s[4:7], s46 offen sc1 lds
    s_add_u32 m0, s39, 16384
    s_add_u32 s46, s38, 16384
    buffer_load_dwordx4 v9, s[4:7], s46 offen sc1 lds
    s_add_u32 m0, s39, 17408
    s_add_u32 s46, s38, 17408
    buffer_load_dwordx4 v9, s[4:7], s46 offen sc1 lds
    s_waitcnt vmcnt(0)
    ds_read_b128 v[16:19], v10 offset:0
    ds_read_b128 v[20:23], v10 offset:1024
    ds_read_b128 v[24:27], v10 offset:8192
    ds_read_b128 v[28:31], v10 offset:9216
    ds_read_b128 v[32:35], v10 offset:16384
    ds_read_b128 v[36:39], v10 offset:17408
    s_add_u32 s48, s48, 1
    s_waitcnt lgkmcnt(5)
    v_max3_u32 v6, v16, v17, 0
    v_max3_u32 v6, v18, v19, v6
    s_waitcnt lgkmcnt(4)
    v_max3_u32 v6, v20, v21, v6
    v_max3_u32 v6, v22, v23, v6
    s_waitcnt lgkmcnt(3)
    v_max3_u32 v6, v24, v25, v6
    v_max3_u32 v6, v26, v27, v6
    s_waitcnt lgkmcnt(2)
    v_max3_u32 v6, v28, v29, v6
    v_max3_u32 v6, v30, v31, v6
    s_waitcnt lgkmcnt(1)
    v_max3_u32 v6, v32, v33, v6
    v_max3_u32 v6, v34, v35, v6
    s_waitcnt lgkmcnt(0)
    v_max3_u32 v6, v36, v37, v6
    v_max3_u32 v6, v38, v39, v6
    v_cmp_eq_u32 vcc, -1, v6
    s_cmp_lt_u32 s48, 262144
    s_cselect_b64 vcc, vcc, 0
    s_cbranch_vccz k2_firstok
    s_sleep 6
    s_branch k2_first
k2_firstok:
    s_barrier
    s_mov_b32 s40, 0xfff8
    s_mov_b32 s41, 3
    s_mov_b32 s48, 0
    s_add_u32 s39, s39, 24576
k2_kv:
    s_mov_b32 exec_hi, 0
    buffer_load_dword v5, v4, s[4:7], s37 offen sc1
    s_mov_b32 exec_hi, -1
    s_waitcnt vmcnt(0) lgkmcnt(0)
    v_cmp_eq_u32 vcc, s97, v5
    s_cmp_ge_u32 s41, 3
    s_cbranch_scc0 k2_kv_pick
    v_lshl_add_u32 v2, s24, 2, 0
    v_mov_b32 v3, s41
    ds_write_b32 v2, v3 offset:16
k2_kv_pick:
    s_lshr_b32 s45, vcc_lo, 16
    s_and_b32 s45, s45, vcc_lo
    s_add_u32 s48, s48, 1
    s_cmp_lt_u32 s48, 262144
    s_cselect_b32 s45, s45, s40
    s_and_b32 s45, s45, s40
    s_cbranch_scc1 k2_kv_next
    s_sleep 8
    s_branch k2_kv
k2_kv_next:
    s_ff1_i32_b32 s46, s45
    s_bitset0_b32 s45, s46
    s_bitset0_b32 s40, s46
    s_lshl_b32 s46, s46, 13
    s_add_u32 s46, s46, s38
    s_mov_b32 m0, s39
    s_add_u32 s47, s46, 1024
    buffer_load_dwordx4 v9, s[4:7], s46 offen sc1 lds
    s_add_u32 m0, s39, 1024
    s_add_u32 s39, s39, 8192
    buffer_load_dwordx4 v9, s[4:7], s47 offen sc1 lds
    s_add_u32 s41, s41, 1
    s_cmp_eq_u32 s41, 3
    s_cbranch_scc1 k2_kv_land
    s_cmp_eq_u32 s41, 9
    s_cbranch_scc1 k2_kv_land2
k2_kv_more:
    s_cmp_lg_u32 s45, 0
    s_cbranch_scc1 k2_kv_next
    s_cmp_lg_u32 s40, 0
    s_cbranch_scc1 k2_kv
    s_branch k2_kv_done
k2_kv_land:
    s_waitcnt vmcnt(0) lgkmcnt(0)
    s_barrier
    s_branch k2_kv_more
k2_kv_land2:
    s_waitcnt vmcnt(6)
    v_lshl_add_u32 v2, s24, 2, 0
    v_mov_b32 v3, 6
    ds_write_b32 v2, v3 offset:16
    s_branch k2_kv_more
k2_kv_done:
    s_cmp_eq_u32 s24, 2
    s_cbranch_scc0 k2_nokeys
    s_mov_b32 s45, 0xa18000
    buffer_load_dwordx4 v[16:19], v9, s[4:7], s45 offen sc1
    s_mov_b32 s45, 0xa18400
    buffer_load_dwordx4 v[20:23], v9, s[4:7], s45 offen sc1
    s_mov_b32 s45, 0xa18800
    buffer_load_dwordx4 v[24:27], v9, s[4:7], s45 offen sc1
    s_mov_b32 s45, 0xa18c00
    buffer_load_dwordx4 v[28:31], v9, s[4:7], s45 offen sc1
    s_mov_b32 s45, 0xa19000
    buffer_load_dwordx4 v[32:35], v9, s[4:7], s45 offen sc1
    s_mov_b32 s45, 0xa19400
    buffer_load_dwordx4 v[36:39], v9, s[4:7], s45 offen sc1
    s_mov_b32 s45, 0xa19800
    buffer_load_dwordx4 v[40:43], v9, s[4:7], s45 offen sc1
    s_mov_b32 s45, 0xa19c00
    buffer_load_dwordx4 v[44:47], v9, s[4:7], s45 offen sc1
    s_mov_b32 s45, 0xa1a000
    buffer_load_dwordx4 v[48:51], v9, s[4:7], s45 offen sc1
    s_mov_b32 s45, 0xa1a400
    buffer_load_dwordx4 v[52:55], v9, s[4:7], s45 offen sc1
    s_mov_b32 s45, 0xa1a800
    buffer_load_dwordx4 v[56:59], v9, s[4:7], s45 offen sc1
    s_mov_b32 s45, 0xa1ac00
    buffer_load_dwordx4 v[60:63], v9, s[4:7], s45 offen sc1
    s_mov_b32 s45, 0xa1b000
    buffer_load_dwordx4 v[64:67], v9, s[4:7], s45 offen sc1
    s_mov_b32 s45, 0xa1b400
    buffer_load_dwordx4 v[68:71], v9, s[4:7], s45 offen sc1
    s_mov_b32 s45, 0xa1b800
    buffer_load_dwordx4 v[72:75], v9, s[4:7], s45 offen sc1
    s_mov_b32 s45, 0xa1bc00
    buffer_load_dwordx4 v[76:79], v9, s[4:7], s45 offen sc1
k2_nokeys:
    s_lshl_b32 s45, s27, 9
    s_lshl_b32 s46, s24, 3
    s_add_u32 s45, s45, s46
    s_add_u32 s45, s45, 0xa1c000
    v_and_b32 v4, 15, v8
    v_lshlrev_b32 v4, 5, v4
    v_mov_b32 v2, 0
    buffer_load_dwordx2 v[6:7], v4, s[4:7], s45 offen sc1
    s_mov_b32 s51, s45
    v_mov_b32 v10, v4
    s_lshl_b32 s42, s99, 10
    s_add_u32 s42, s42, 0x800000
    s_add_u32 s43, s42, 1024
    buffer_store_dwordx4 v[108:111], v9, s[4:7], s42 offen sc1
    buffer_store_dwordx4 v[112:115], v9, s[4:7], s43 offen sc1
    s_lshl_b32 s99, s99, 6
    s_add_u32 s99, s99, 0xaa0000
    s_waitcnt vmcnt(2)
    s_branch k2_knc
k2_knp:
    buffer_load_dwordx2 v[6:7], v10, s[4:7], s51 offen sc1
    s_waitcnt vmcnt(0)
k2_knc:
    s_add_u32 s48, s48, 1
    v_cmp_ne_u32 vcc, s97, v7
    s_cmp_lt_u32 s48, 262144
    s_cselect_b64 vcc, vcc, 0
    s_cbranch_vccnz k2_knp
    s_mov_b64 exec, 0xffff
    ds_max_u32 v2, v6 offset:4
    s_mov_b64 exec, -1
    v_lshl_add_u32 v2, s24, 2, 0
    v_mov_b32 v3, 16
    ds_write_b32 v2, v3 offset:16
    v_mov_b32 v2, s97
    v_mov_b32 v3, 0
    v_mov_b32 v5, 1
    s_waitcnt vmcnt(0)
    s_mov_b64 exec, 1
    ds_add_u32 v3, v5 offset:8
    buffer_store_dword v2, v3, s[4:7], s99 offen sc1
    s_mov_b64 exec, -1
    s_cmp_eq_u32 s24, 2
    s_cbranch_scc0 k2_ranked
    s_mov_b32 s48, 0
    s_branch k2_kchk
k2_kpoll:
    s_mov_b32 s45, 0xa18000
    buffer_load_dwordx4 v[16:19], v9, s[4:7], s45 offen sc1
    s_mov_b32 s45, 0xa18400
    buffer_load_dwordx4 v[20:23], v9, s[4:7], s45 offen sc1
    s_mov_b32 s45, 0xa18800
    buffer_load_dwordx4 v[24:27], v9, s[4:7], s45 offen sc1
    s_mov_b32 s45, 0xa18c00
    buffer_load_dwordx4 v[28:31], v9, s[4:7], s45 offen sc1
    s_mov_b32 s45, 0xa19000
    buffer_load_dwordx4 v[32:35], v9, s[4:7], s45 offen sc1
    s_mov_b32 s45, 0xa19400
    buffer_load_dwordx4 v[36:39], v9, s[4:7], s45 offen sc1
    s_mov_b32 s45, 0xa19800
    buffer_load_dwordx4 v[40:43], v9, s[4:7], s45 offen sc1
    s_mov_b32 s45, 0xa19c00
    buffer_load_dwordx4 v[44:47], v9, s[4:7], s45 offen sc1
    s_mov_b32 s45, 0xa1a000
    buffer_load_dwordx4 v[48:51], v9, s[4:7], s45 offen sc1
    s_mov_b32 s45, 0xa1a400
    buffer_load_dwordx4 v[52:55], v9, s[4:7], s45 offen sc1
    s_mov_b32 s45, 0xa1a800
    buffer_load_dwordx4 v[56:59], v9, s[4:7], s45 offen sc1
    s_mov_b32 s45, 0xa1ac00
    buffer_load_dwordx4 v[60:63], v9, s[4:7], s45 offen sc1
    s_mov_b32 s45, 0xa1b000
    buffer_load_dwordx4 v[64:67], v9, s[4:7], s45 offen sc1
    s_mov_b32 s45, 0xa1b400
    buffer_load_dwordx4 v[68:71], v9, s[4:7], s45 offen sc1
    s_mov_b32 s45, 0xa1b800
    buffer_load_dwordx4 v[72:75], v9, s[4:7], s45 offen sc1
    s_mov_b32 s45, 0xa1bc00
    buffer_load_dwordx4 v[76:79], v9, s[4:7], s45 offen sc1
    s_waitcnt vmcnt(0)
k2_kchk:
    v_xor_b32 v4, s97, v17
    v_bitop3_b32 v4, v4, v19, s97 bitop3:0xf6
    v_bitop3_b32 v4, v4, v21, s97 bitop3:0xf6
    v_bitop3_b32 v4, v4, v23, s97 bitop3:0xf6
    v_bitop3_b32 v4, v4, v25, s97 bitop3:0xf6
    v_bitop3_b32 v4, v4, v27, s97 bitop3:0xf6
    v_bitop3_b32 v4, v4, v29, s97 bitop3:0xf6
    v_bitop3_b32 v4, v4, v31, s97 bitop3:0xf6
    v_bitop3_b32 v4, v4, v33, s97 bitop3:0xf6
    v_bitop3_b32 v4, v4, v35, s97 bitop3:0xf6
    v_bitop3_b32 v4, v4, v37, s97 bitop3:0xf6
    v_bitop3_b32 v4, v4, v39, s97 bitop3:0xf6
    v_bitop3_b32 v4, v4, v41, s97 bitop3:0xf6
    v_bitop3_b32 v4, v4, v43, s97 bitop3:0xf6
    v_bitop3_b32 v4, v4, v45, s97 bitop3:0xf6
    v_bitop3_b32 v4, v4, v47, s97 bitop3:0xf6
    v_bitop3_b32 v4, v4, v49, s97 bitop3:0xf6
    v_bitop3_b32 v4, v4, v51, s97 bitop3:0xf6
    v_bitop3_b32 v4, v4, v53, s97 bitop3:0xf6
    v_bitop3_b32 v4, v4, v55, s97 bitop3:0xf6
    v_bitop3_b32 v4, v4, v57, s97 bitop3:0xf6
    v_bitop3_b32 v4, v4, v59, s97 bitop3:0xf6
    v_bitop3_b32 v4, v4, v61, s97 bitop3:0xf6
    v_bitop3_b32 v4, v4, v63, s97 bitop3:0xf6
    v_bitop3_b32 v4, v4, v65, s97 bitop3:0xf6
    v_bitop3_b32 v4, v4, v67, s97 bitop3:0xf6
    v_bitop3_b32 v4, v4, v69, s97 bitop3:0xf6
    v_bitop3_b32 v4, v4, v71, s97 bitop3:0xf6
    v_bitop3_b32 v4, v4, v73, s97 bitop3:0xf6
    v_bitop3_b32 v4, v4, v75, s97 bitop3:0xf6
    v_bitop3_b32 v4, v4, v77, s97 bitop3:0xf6
    v_bitop3_b32 v4, v4, v79, s97 bitop3:0xf6
    v_cmp_ne_u32 vcc, 0, v4
    s_cbranch_vccz k2_kok
    s_sleep 16
    s_add_u32 s48, s48, 1
    s_cmp_lt_u32 s48, 262144
    s_cbranch_scc1 k2_kpoll
k2_kok:
    v_max3_u32 v4, v16, v18, v20
    v_max3_u32 v5, v22, v24, v26
    v_max3_u32 v4, v28, v30, v4
    v_max3_u32 v5, v32, v34, v5
    v_max3_u32 v4, v36, v38, v4
    v_max3_u32 v5, v40, v42, v5
    v_max3_u32 v4, v44, v46, v4
    v_max3_u32 v5, v48, v50, v5
    v_max3_u32 v4, v52, v54, v4
    v_max3_u32 v5, v56, v58, v5
    v_max3_u32 v4, v60, v62, v4
    v_max3_u32 v5, v64, v66, v5
    v_max3_u32 v4, v68, v70, v4
    v_max3_u32 v5, v72, v74, v5
    v_max3_u32 v4, v76, v78, v4
    v_max_u32 v4, v4, v5
    s_max_u32 s45, s56, s57
    s_max_u32 s45, s45, s58
    s_max_u32 s45, s45, s59
    s_max_u32 s45, s45, s60
    s_max_u32 s45, s45, s61
    s_max_u32 s45, s45, s62
    s_max_u32 s45, s45, s63
    v_cmp_lt_u32 vcc, s45, v4
    s_bcnt1_i32_b64 s46, vcc
    s_cmp_ge_u32 s46, 8
    s_cbranch_scc1 k2_ranked
    s_mov_b32 s47, 0
k2_rank_loop:
    v_cmp_lt_u32 vcc, s56, v4
    s_bcnt1_i32_b64 s46, vcc
    s_cmp_ge_u32 s46, 8
    s_cbranch_scc1 k2_rank_next
    s_mov_b32 s46, 0
    v_cmp_lt_u32 vcc, s56, v16
    v_cmp_lt_u32 s[44:45], s56, v18
    v_cmp_lt_u32 s[48:49], s56, v20
    v_cmp_lt_u32 s[50:51], s56, v22
    s_bcnt1_i32_b64 s42, vcc
    s_add_u32 s46, s46, s42
    s_bcnt1_i32_b64 s42, s[44:45]
    s_add_u32 s46, s46, s42
    s_bcnt1_i32_b64 s42, s[48:49]
    s_add_u32 s46, s46, s42
    s_bcnt1_i32_b64 s42, s[50:51]
    s_add_u32 s46, s46, s42
    v_cmp_lt_u32 vcc, s56, v24
    v_cmp_lt_u32 s[44:45], s56, v26
    v_cmp_lt_u32 s[48:49], s56, v28
    v_cmp_lt_u32 s[50:51], s56, v30
    s_bcnt1_i32_b64 s42, vcc
    s_add_u32 s46, s46, s42
    s_bcnt1_i32_b64 s42, s[44:45]
    s_add_u32 s46, s46, s42
    s_bcnt1_i32_b64 s42, s[48:49]
    s_add_u32 s46, s46, s42
    s_bcnt1_i32_b64 s42, s[50:51]
    s_add_u32 s46, s46, s42
    v_cmp_lt_u32 vcc, s56, v32
    v_cmp_lt_u32 s[44:45], s56, v34
    v_cmp_lt_u32 s[48:49], s56, v36
    v_cmp_lt_u32 s[50:51], s56, v38
    s_bcnt1_i32_b64 s42, vcc
    s_add_u32 s46, s46, s42
    s_bcnt1_i32_b64 s42, s[44:45]
    s_add_u32 s46, s46, s42
    s_bcnt1_i32_b64 s42, s[48:49]
    s_add_u32 s46, s46, s42
    s_bcnt1_i32_b64 s42, s[50:51]
    s_add_u32 s46, s46, s42
    v_cmp_lt_u32 vcc, s56, v40
    v_cmp_lt_u32 s[44:45], s56, v42
    v_cmp_lt_u32 s[48:49], s56, v44
    v_cmp_lt_u32 s[50:51], s56, v46
    s_bcnt1_i32_b64 s42, vcc
    s_add_u32 s46, s46, s42
    s_bcnt1_i32_b64 s42, s[44:45]
    s_add_u32 s46, s46, s42
    s_bcnt1_i32_b64 s42, s[48:49]
    s_add_u32 s46, s46, s42
    s_bcnt1_i32_b64 s42, s[50:51]
    s_add_u32 s46, s46, s42
    v_cmp_lt_u32 vcc, s56, v48
    v_cmp_lt_u32 s[44:45], s56, v50
    v_cmp_lt_u32 s[48:49], s56, v52
    v_cmp_lt_u32 s[50:51], s56, v54
    s_bcnt1_i32_b64 s42, vcc
    s_add_u32 s46, s46, s42
    s_bcnt1_i32_b64 s42, s[44:45]
    s_add_u32 s46, s46, s42
    s_bcnt1_i32_b64 s42, s[48:49]
    s_add_u32 s46, s46, s42
    s_bcnt1_i32_b64 s42, s[50:51]
    s_add_u32 s46, s46, s42
    v_cmp_lt_u32 vcc, s56, v56
    v_cmp_lt_u32 s[44:45], s56, v58
    v_cmp_lt_u32 s[48:49], s56, v60
    v_cmp_lt_u32 s[50:51], s56, v62
    s_bcnt1_i32_b64 s42, vcc
    s_add_u32 s46, s46, s42
    s_bcnt1_i32_b64 s42, s[44:45]
    s_add_u32 s46, s46, s42
    s_bcnt1_i32_b64 s42, s[48:49]
    s_add_u32 s46, s46, s42
    s_bcnt1_i32_b64 s42, s[50:51]
    s_add_u32 s46, s46, s42
    v_cmp_lt_u32 vcc, s56, v64
    v_cmp_lt_u32 s[44:45], s56, v66
    v_cmp_lt_u32 s[48:49], s56, v68
    v_cmp_lt_u32 s[50:51], s56, v70
    s_bcnt1_i32_b64 s42, vcc
    s_add_u32 s46, s46, s42
    s_bcnt1_i32_b64 s42, s[44:45]
    s_add_u32 s46, s46, s42
    s_bcnt1_i32_b64 s42, s[48:49]
    s_add_u32 s46, s46, s42
    s_bcnt1_i32_b64 s42, s[50:51]
    s_add_u32 s46, s46, s42
    v_cmp_lt_u32 vcc, s56, v72
    v_cmp_lt_u32 s[44:45], s56, v74
    v_cmp_lt_u32 s[48:49], s56, v76
    v_cmp_lt_u32 s[50:51], s56, v78
    s_bcnt1_i32_b64 s42, vcc
    s_add_u32 s46, s46, s42
    s_bcnt1_i32_b64 s42, s[44:45]
    s_add_u32 s46, s46, s42
    s_bcnt1_i32_b64 s42, s[48:49]
    s_add_u32 s46, s46, s42
    s_bcnt1_i32_b64 s42, s[50:51]
    s_add_u32 s46, s46, s42
    s_cmp_ge_u32 s46, 8
    s_cbranch_scc1 k2_rank_next
    v_mov_b32 v5, 0
k2_xcw:
    ds_read_b32 v6, v5 offset:8
    s_waitcnt lgkmcnt(0)
    v_readfirstlane_b32 s42, v6
    s_cmp_lt_u32 s42, 4
    s_cbranch_scc1 k2_xcw
    s_lshl_b32 s46, s46, 3
    s_add_u32 s46, s46, 0xa06000
    v_mov_b32 v6, s56
    v_mov_b32 v7, s97
    v_mov_b32 v5, 0
    s_mov_b64 exec, 1
    buffer_store_dwordx2 v[6:7], v5, s[4:7], s46 offen sc1
    s_mov_b64 exec, -1
k2_rank_next:
    s_mov_b32 s56, s57
    s_mov_b32 s57, s58
    s_mov_b32 s58, s59
    s_mov_b32 s59, s60
    s_mov_b32 s60, s61
    s_mov_b32 s61, s62
    s_mov_b32 s62, s63
    s_add_u32 s47, s47, 1
    s_cmp_lt_u32 s47, 8
    s_cbranch_scc1 k2_rank_loop
k2_ranked:
    s_cmp_eq_u32 s24, 1
    s_cbranch_scc0 k2_notouch
    s_mul_i32 s42, s26, 57344
    s_lshl_b32 s43, s25, 7
    s_add_u32 s42, s42, s43
    v_lshlrev_b32 v6, 10, v8
    buffer_load_dword v122, v6, s[16:19], s42 offen
k2_notouch:
    s_cmp_lt_u32 s26, 28
    s_cbranch_scc0 k2_nostage
    s_mul_i32 s49, s25, 28
    s_add_u32 s49, s49, s26
    s_lshl_b32 s49, s49, 4
    s_mul_i32 s46, s24, 458752
    s_add_u32 s45, s49, s46
    s_movk_i32 s46, 3584
    v_mul_u32_u24 v4, s46, v8
    s_lshl_b32 s46, s24, 11
    s_add_u32 m0, s46, 128
    s_nop 0
    buffer_load_dwordx4 v4, s[8:11], s45 offen lds
    s_add_u32 m0, s46, 8384
    s_nop 0
    buffer_load_dwordx4 v4, s[12:15], s45 offen lds
    s_add_u32 s45, s45, 229376
    s_add_u32 m0, s46, 1152
    s_nop 0
    buffer_load_dwordx4 v4, s[8:11], s45 offen lds
    s_add_u32 m0, s46, 9408
    s_nop 0
    buffer_load_dwordx4 v4, s[12:15], s45 offen lds
    s_branch k2_flagged
k2_nostage:
    s_lshl_b32 s46, s25, 2
    s_add_u32 s46, s46, s26
    s_sub_u32 s46, s46, 28
    s_lshl_b32 s46, s46, 5
    v_mov_b32 v2, 0
k2_lw_21:
    ds_read_b128 v[4:7], v2 offset:32
    ds_read_b128 v[12:15], v2 offset:48
    s_waitcnt lgkmcnt(0)
    v_min3_u32 v4, v4, v5, v6
    v_min3_u32 v4, v4, v7, v12
    v_min3_u32 v4, v4, v13, v14
    v_min_u32 v4, v4, v15
    s_nop 0
    v_readfirstlane_b32 s45, v4
    s_cmp_ge_u32 s45, 2
    s_cbranch_scc1 k2_lg_22
    s_sleep 8
    s_branch k2_lw_21
k2_lg_22:
    s_mul_i32 s45, s24, 458752
    s_add_u32 s45, s45, s46
    s_mul_i32 s46, s24, 14336
    v_lshrrev_b32 v4, 1, v8
    v_and_b32 v5, 1, v8
    v_lshlrev_b32 v5, 4, v5
    v_lshl_add_u32 v4, v4, 10, v5
    s_add_u32 m0, s46, 128
    s_nop 0
    buffer_load_dwordx4 v4, s[16:19], s45 offen lds
    s_add_u32 s45, s45, 32768
    s_add_u32 m0, s46, 1152
    s_nop 0
    buffer_load_dwordx4 v4, s[16:19], s45 offen lds
    s_add_u32 s45, s45, 32768
    s_add_u32 m0, s46, 2176
    s_nop 0
    buffer_load_dwordx4 v4, s[16:19], s45 offen lds
    s_add_u32 s45, s45, 32768
    s_add_u32 m0, s46, 3200
    s_nop 0
    buffer_load_dwordx4 v4, s[16:19], s45 offen lds
    s_add_u32 s45, s45, 32768
    s_add_u32 m0, s46, 4224
    s_nop 0
    buffer_load_dwordx4 v4, s[16:19], s45 offen lds
    s_add_u32 s45, s45, 32768
    s_add_u32 m0, s46, 5248
    s_nop 0
    buffer_load_dwordx4 v4, s[16:19], s45 offen lds
    s_add_u32 s45, s45, 32768
    s_add_u32 m0, s46, 6272
    s_nop 0
    buffer_load_dwordx4 v4, s[16:19], s45 offen lds
    s_add_u32 s45, s45, 32768
    s_add_u32 m0, s46, 7296
    s_nop 0
    buffer_load_dwordx4 v4, s[16:19], s45 offen lds
    s_add_u32 s45, s45, 32768
    s_add_u32 m0, s46, 8320
    s_nop 0
    buffer_load_dwordx4 v4, s[16:19], s45 offen lds
    s_add_u32 s45, s45, 32768
    s_add_u32 m0, s46, 9344
    s_nop 0
    buffer_load_dwordx4 v4, s[16:19], s45 offen lds
    s_add_u32 s45, s45, 32768
    s_add_u32 m0, s46, 10368
    s_nop 0
    buffer_load_dwordx4 v4, s[16:19], s45 offen lds
    s_add_u32 s45, s45, 32768
    s_add_u32 m0, s46, 11392
    s_nop 0
    buffer_load_dwordx4 v4, s[16:19], s45 offen lds
    s_add_u32 s45, s45, 32768
    s_add_u32 m0, s46, 12416
    s_nop 0
    buffer_load_dwordx4 v4, s[16:19], s45 offen lds
    s_add_u32 s45, s45, 32768
    s_add_u32 m0, s46, 13440
    s_nop 0
    buffer_load_dwordx4 v4, s[16:19], s45 offen lds
k2_flagged:
    s_cmp_eq_u32 s24, 3
    s_cbranch_scc0 k2_lsel
    s_mov_b32 s46, 0xa06000
    s_mov_b32 s48, 0
    v_lshlrev_b32 v2, 1, v117
k2_psel:
    buffer_load_dwordx2 v[120:121], v2, s[4:7], s46 offen sc1
    s_waitcnt vmcnt(0)
    v_cmp_ne_u32 vcc, s97, v121
    s_cbranch_vccz k2_psel_ok
    s_sleep 8
    s_add_u32 s48, s48, 1
    s_cmp_lt_u32 s48, 262144
    s_cbranch_scc1 k2_psel
k2_psel_ok:
    v_or_b32 v120, 0x8000, v120
    ds_write_b32 v117, v120 offset:64
k2_lsel:
    ds_read_b32 v123, v117 offset:64
    s_waitcnt lgkmcnt(0)
    v_cmp_eq_u32 vcc, 0, v123
    s_cbranch_vccz k2_gsel
    s_sleep 16
    s_branch k2_lsel
k2_gsel:
    v_mov_b32 v12, -1
    v_mov_b32 v13, -1
    v_mov_b32 v14, -1
    v_mov_b32 v15, -1
    s_lshl_b32 s42, s28, 2
    s_add_u32 s42, s42, s24
    s_lshl_b32 s98, s42, 5
    s_add_u32 s98, s98, s27
    s_lshl_b32 s98, s98, 7
    s_add_u32 s98, s98, 0xa60000
    s_lshl_b32 s42, s42, 16
    s_lshl_b32 s43, s27, 10
    s_add_u32 s42, s42, s43
    s_add_u32 s42, s42, 0x600000
    s_add_u32 s43, s42, 32768
    buffer_store_dwordx4 v[12:15], v9, s[4:7], s42 offen sc1
    buffer_store_dwordx4 v[12:15], v9, s[4:7], s43 offen sc1
    v_and_b32 v11, 0x7ff, v123
    v_sub_u32 v11, 0x7ff, v11
    v_and_b32 v12, 48, v8
    v_lshrrev_b32 v5, 4, v8
    s_cmp_lt_u32 s26, 28
    s_cbranch_scc0 k2_stepB
    v_lshl_add_u32 v4, v11, 10, v12
    s_lshl_b32 s46, s24, 8
    s_add_u32 s46, s46, 0x800000
    buffer_load_dwordx4 v[16:19], v4, s[4:7], s46 offen offset:0 sc1
    buffer_load_dwordx4 v[20:23], v4, s[4:7], s46 offen offset:64 sc1
    buffer_load_dwordx4 v[24:27], v4, s[4:7], s46 offen offset:128 sc1
    buffer_load_dwordx4 v[28:31], v4, s[4:7], s46 offen offset:192 sc1
    v_bfe_u32 v6, v8, 2, 2
    v_lshl_add_u32 v6, v5, 3, v6
    v_lshlrev_b32 v6, 4, v6
    v_and_b32 v7, 1, v8
    v_lshl_add_u32 v6, v7, 3, v6
    v_bfe_u32 v7, v8, 1, 1
    s_movk_i32 s47, 8256
    v_mad_u32_u24 v6, v7, s47, v6
    v_lshl_add_u32 v6, s24, 11, v6
    s_waitcnt vmcnt(0)
    v_mov_b32 v2, s97
    v_mov_b32 v3, 0
    s_mov_b64 exec, 1
    buffer_store_dword v2, v3, s[4:7], s98 offen sc1
    s_mov_b64 exec, -1
    ds_read_b64_tr_b16 v[80:81], v6 offset:128
    ds_read_b64_tr_b16 v[82:83], v6 offset:192
    ds_read_b64_tr_b16 v[84:85], v6 offset:640
    ds_read_b64_tr_b16 v[86:87], v6 offset:704
    ds_read_b64_tr_b16 v[88:89], v6 offset:1152
    ds_read_b64_tr_b16 v[90:91], v6 offset:1216
    ds_read_b64_tr_b16 v[92:93], v6 offset:1664
    ds_read_b64_tr_b16 v[94:95], v6 offset:1728
    s_waitcnt lgkmcnt(6)
    v_mfma_f32_16x16x32_bf16 v[96:99], v[80:83], v[16:19], 0
    s_waitcnt lgkmcnt(4)
    v_mfma_f32_16x16x32_bf16 v[96:99], v[84:87], v[20:23], v[96:99]
    s_waitcnt lgkmcnt(2)
    v_mfma_f32_16x16x32_bf16 v[96:99], v[88:91], v[24:27], v[96:99]
    s_waitcnt lgkmcnt(0)
    v_mfma_f32_16x16x32_bf16 v[96:99], v[92:95], v[28:31], v[96:99]
    v_lshl_add_u32 v6, s24, 10, v9
    v_mov_b32 v7, 0
    v_mov_b32 v10, 1
    s_mov_b32 exec_lo, 0x00ff00ff
    s_mov_b32 exec_hi, 0x00ff00ff
    s_nop 2
    ds_write_b128 v6, v[96:99] offset:16640
    s_mov_b64 exec, 1
    ds_add_u32 v7, v10 offset:0
    s_mov_b64 exec, -1
    s_cmp_eq_u32 s24, 0
    s_cbranch_scc0 k2_gate
k2_aw_23:
    ds_read_b32 v10, v7 offset:0
    s_waitcnt lgkmcnt(0)
    v_readfirstlane_b32 s46, v10
    s_cmp_ge_u32 s46, 4
    s_cbranch_scc1 k2_ag_24
    s_sleep 4
    s_branch k2_aw_23
k2_ag_24:
    ds_read_b128 v[16:19], v9 offset:16640
    ds_read_b128 v[20:23], v9 offset:17664
    ds_read_b128 v[24:27], v9 offset:18688
    ds_read_b128 v[28:31], v9 offset:19712
    v_mov_b32 v10, 5
    ds_write_b32 v7, v10 offset:0
    s_waitcnt lgkmcnt(0)
    v_add_f32 v16, v16, v20
    v_add_f32 v24, v24, v28
    v_add_f32 v17, v17, v21
    v_add_f32 v25, v25, v29
    v_add_f32 v18, v18, v22
    v_add_f32 v26, v26, v30
    v_add_f32 v19, v19, v23
    v_add_f32 v27, v27, v31
    v_add_f32 v16, v16, v24
    v_add_f32 v17, v17, v25
    v_add_f32 v18, v18, v26
    v_add_f32 v19, v19, v27
    s_movk_i32 s47, 896
    v_lshlrev_b32 v5, 3, v5
    v_mad_u32_u24 v4, v117, s47, v5
    s_add_u32 s45, s49, 0xa08000
    v_cvt_pk_bf16_f32 v17, v16, v17
    v_cvt_pk_bf16_f32 v19, v18, v19
    v_lshlrev_b32 v16, 16, v17
    v_and_b32 v17, 0xffff0000, v17
    v_lshlrev_b32 v18, 16, v19
    v_and_b32 v19, 0xffff0000, v19
    v_mov_b32 v100, v16
    v_mov_b32 v101, v17
    v_mov_b32 v102, v18
    v_mov_b32 v103, v19
    v_permlane32_swap_b32 v16, v100
    v_permlane32_swap_b32 v17, v101
    v_permlane32_swap_b32 v18, v102
    v_permlane32_swap_b32 v19, v103
    v_mul_f32 v104, 0xbfb8aa3b, v16
    v_mul_f32 v105, 0xbfb8aa3b, v17
    v_mul_f32 v106, 0xbfb8aa3b, v18
    v_mul_f32 v107, 0xbfb8aa3b, v19
    v_exp_f32 v104, v104
    v_exp_f32 v105, v105
    v_exp_f32 v106, v106
    v_exp_f32 v107, v107
    v_add_f32 v104, 1.0, v104
    v_add_f32 v105, 1.0, v105
    v_add_f32 v106, 1.0, v106
    v_add_f32 v107, 1.0, v107
    v_rcp_f32 v104, v104
    v_rcp_f32 v105, v105
    v_rcp_f32 v106, v106
    v_rcp_f32 v107, v107
    v_mul_f32 v16, v16, v104
    v_mul_f32 v17, v17, v105
    v_mul_f32 v18, v18, v106
    v_mul_f32 v19, v19, v107
    v_cvt_pk_bf16_f32 v17, v16, v17
    v_cvt_pk_bf16_f32 v19, v18, v19
    v_lshlrev_b32 v16, 16, v17
    v_and_b32 v17, 0xffff0000, v17
    v_lshlrev_b32 v18, 16, v19
    v_and_b32 v19, 0xffff0000, v19
    v_mul_f32 v16, v16, v100
    v_mul_f32 v17, v17, v101
    v_mul_f32 v18, v18, v102
    v_mul_f32 v19, v19, v103
    v_cvt_pk_bf16_f32 v100, v16, v17
    v_cvt_pk_bf16_f32 v101, v18, v19
    v_min_u32 v100, -2, v100
    v_min_u32 v101, -2, v101
    s_mov_b64 exec, 0x00ff00ff
    buffer_store_dwordx2 v[100:101], v4, s[4:7], s45 offen sc1
    s_mov_b64 exec, -1
    s_branch k2_gate
k2_stepB:
    s_lshl_b32 s49, s25, 2
    s_add_u32 s49, s49, s26
    s_sub_u32 s49, s49, 28
    v_lshrrev_b32 v7, 1, v12
    v_lshl_add_u32 v6, v11, 10, v7
    s_lshl_b32 s46, s49, 5
    s_add_u32 s47, s46, 0x800000
    buffer_load_dwordx2 v[100:101], v6, s[4:7], s47 offen sc1
    s_movk_i32 s47, 896
    v_mad_u32_u24 v11, v117, s47, v12
    s_mul_i32 s46, s24, 14336
    s_sleep 24
    s_mul_i32 s50, s24, 896
    s_add_u32 s50, s50, 0xa08000
    s_mov_b32 s48, 0
    v_min_u32 v6, 55, v8
    v_lshlrev_b32 v6, 4, v6
    v_add_u32 v6, 25088, v6
k2_b_look:
    buffer_load_dword v7, v6, s[4:7], s50 offen offset:12 sc1
    s_add_u32 s48, s48, 1
    s_waitcnt vmcnt(0)
    v_cmp_eq_u32 vcc, -1, v7
    s_cmp_lt_u32 s48, 262144
    s_cselect_b64 vcc, vcc, 0
    s_cbranch_vccz k2_b_poll
    s_sleep 12
    s_branch k2_b_look
k2_b_poll:
    buffer_load_dwordx4 v[16:19], v11, s[4:7], s50 offen offset:0 sc1
    buffer_load_dwordx4 v[20:23], v11, s[4:7], s50 offen offset:64 sc1
    buffer_load_dwordx4 v[24:27], v11, s[4:7], s50 offen offset:128 sc1
    buffer_load_dwordx4 v[28:31], v11, s[4:7], s50 offen offset:192 sc1
    buffer_load_dwordx4 v[32:35], v11, s[4:7], s50 offen offset:256 sc1
    buffer_load_dwordx4 v[36:39], v11, s[4:7], s50 offen offset:320 sc1
    buffer_load_dwordx4 v[40:43], v11, s[4:7], s50 offen offset:384 sc1
    buffer_load_dwordx4 v[44:47], v11, s[4:7], s50 offen offset:448 sc1
    buffer_load_dwordx4 v[48:51], v11, s[4:7], s50 offen offset:512 sc1
    buffer_load_dwordx4 v[52:55], v11, s[4:7], s50 offen offset:576 sc1
    buffer_load_dwordx4 v[56:59], v11, s[4:7], s50 offen offset:640 sc1
    buffer_load_dwordx4 v[60:63], v11, s[4:7], s50 offen offset:704 sc1
    buffer_load_dwordx4 v[64:67], v11, s[4:7], s50 offen offset:768 sc1
    buffer_load_dwordx4 v[68:71], v11, s[4:7], s50 offen offset:832 sc1
    s_waitcnt vmcnt(0)
    v_max_u32 v6, v16, v18
    v_max3_u32 v6, v20, v22, v6
    v_max3_u32 v6, v24, v26, v6
    v_max3_u32 v6, v28, v30, v6
    v_max3_u32 v6, v32, v34, v6
    v_max3_u32 v6, v36, v38, v6
    v_max3_u32 v6, v40, v42, v6
    v_max3_u32 v6, v44, v46, v6
    v_max3_u32 v6, v48, v50, v6
    v_max3_u32 v6, v52, v54, v6
    v_max3_u32 v6, v56, v58, v6
    v_max3_u32 v6, v60, v62, v6
    v_max3_u32 v6, v64, v66, v6
    v_max3_u32 v6, v68, v70, v6
    v_cmp_eq_u32 vcc, -1, v6
    s_cbranch_vccz k2_b_go
    s_sleep 16
    s_add_u32 s48, s48, 1
    s_cmp_lt_u32 s48, 262144
    s_cbranch_scc1 k2_b_poll
k2_b_go:
    v_mov_b32 v2, s97
    v_mov_b32 v3, 0
    s_mov_b64 exec, 1
    buffer_store_dword v2, v3, s[4:7], s98 offen sc1
    s_mov_b64 exec, -1
    v_bfe_u32 v6, v8, 2, 2
    v_lshl_add_u32 v6, v5, 3, v6
    v_lshlrev_b32 v6, 5, v6
    v_and_b32 v7, 3, v8
    v_lshl_add_u32 v6, v7, 3, v6
    v_add_u32 v6, s46, v6
    ds_read_b64_tr_b16 v[80:81], v6 offset:128
    ds_read_b64_tr_b16 v[82:83], v6 offset:256
    ds_read_b64_tr_b16 v[84:85], v6 offset:1152
    ds_read_b64_tr_b16 v[86:87], v6 offset:1280
    ds_read_b64_tr_b16 v[88:89], v6 offset:2176
    ds_read_b64_tr_b16 v[90:91], v6 offset:2304
    ds_read_b64_tr_b16 v[92:93], v6 offset:3200
    ds_read_b64_tr_b16 v[94:95], v6 offset:3328
    s_waitcnt lgkmcnt(6)
    v_mfma_f32_16x16x32_bf16 v[96:99], v[80:83], v[16:19], 0
    ds_read_b64_tr_b16 v[80:81], v6 offset:4224
    ds_read_b64_tr_b16 v[82:83], v6 offset:4352
    s_waitcnt lgkmcnt(6)
    v_mfma_f32_16x16x32_bf16 v[96:99], v[84:87], v[20:23], v[96:99]
    ds_read_b64_tr_b16 v[84:85], v6 offset:5248
    ds_read_b64_tr_b16 v[86:87], v6 offset:5376
    s_waitcnt lgkmcnt(6)
    v_mfma_f32_16x16x32_bf16 v[96:99], v[88:91], v[24:27], v[96:99]
    ds_read_b64_tr_b16 v[88:89], v6 offset:6272
    ds_read_b64_tr_b16 v[90:91], v6 offset:6400
    s_waitcnt lgkmcnt(6)
    v_mfma_f32_16x16x32_bf16 v[96:99], v[92:95], v[28:31], v[96:99]
    ds_read_b64_tr_b16 v[92:93], v6 offset:7296
    ds_read_b64_tr_b16 v[94:95], v6 offset:7424
    s_waitcnt lgkmcnt(6)
    v_mfma_f32_16x16x32_bf16 v[96:99], v[80:83], v[32:35], v[96:99]
    ds_read_b64_tr_b16 v[80:81], v6 offset:8320
    ds_read_b64_tr_b16 v[82:83], v6 offset:8448
    s_waitcnt lgkmcnt(6)
    v_mfma_f32_16x16x32_bf16 v[96:99], v[84:87], v[36:39], v[96:99]
    ds_read_b64_tr_b16 v[84:85], v6 offset:9344
    ds_read_b64_tr_b16 v[86:87], v6 offset:9472
    s_waitcnt lgkmcnt(6)
    v_mfma_f32_16x16x32_bf16 v[96:99], v[88:91], v[40:43], v[96:99]
    ds_read_b64_tr_b16 v[88:89], v6 offset:10368
    ds_read_b64_tr_b16 v[90:91], v6 offset:10496
    s_waitcnt lgkmcnt(6)
    v_mfma_f32_16x16x32_bf16 v[96:99], v[92:95], v[44:47], v[96:99]
    ds_read_b64_tr_b16 v[92:93], v6 offset:11392
    ds_read_b64_tr_b16 v[94:95], v6 offset:11520
    s_waitcnt lgkmcnt(6)
    v_mfma_f32_16x16x32_bf16 v[96:99], v[80:83], v[48:51], v[96:99]
    ds_read_b64_tr_b16 v[80:81], v6 offset:12416
    ds_read_b64_tr_b16 v[82:83], v6 offset:12544
    s_waitcnt lgkmcnt(6)
    v_mfma_f32_16x16x32_bf16 v[96:99], v[84:87], v[52:55], v[96:99]
    ds_read_b64_tr_b16 v[84:85], v6 offset:13440
    ds_read_b64_tr_b16 v[86:87], v6 offset:13568
    s_waitcnt lgkmcnt(6)
    v_mfma_f32_16x16x32_bf16 v[96:99], v[88:91], v[56:59], v[96:99]
    s_waitcnt lgkmcnt(4)
    v_mfma_f32_16x16x32_bf16 v[96:99], v[92:95], v[60:63], v[96:99]
    s_waitcnt lgkmcnt(2)
    v_mfma_f32_16x16x32_bf16 v[96:99], v[80:83], v[64:67], v[96:99]
    s_waitcnt lgkmcnt(0)
    v_mfma_f32_16x16x32_bf16 v[96:99], v[84:87], v[68:71], v[96:99]
    v_lshl_add_u32 v6, s24, 10, v9
    v_mov_b32 v7, 0
    v_mov_b32 v10, 1
    s_mov_b32 exec_lo, 0x00ff00ff
    s_mov_b32 exec_hi, 0x00ff00ff
    s_nop 2
    ds_write_b128 v6, v[96:99] offset:57472
    s_mov_b64 exec, 1
    ds_add_u32 v7, v10 offset:0
    s_mov_b64 exec, -1
    s_cmp_eq_u32 s24, 0
    s_cbranch_scc0 k2_gate
k2_aw_25:
    ds_read_b32 v10, v7 offset:0
    s_waitcnt lgkmcnt(0)
    v_readfirstlane_b32 s46, v10
    s_cmp_ge_u32 s46, 4
    s_cbranch_scc1 k2_ag_26
    s_sleep 4
    s_branch k2_aw_25
k2_ag_26:
    ds_read_b128 v[16:19], v9 offset:57472
    ds_read_b128 v[20:23], v9 offset:58496
    ds_read_b128 v[24:27], v9 offset:59520
    ds_read_b128 v[28:31], v9 offset:60544
    v_mov_b32 v10, 5
    ds_write_b32 v7, v10 offset:0
    s_waitcnt lgkmcnt(0)
    v_add_f32 v16, v16, v20
    v_add_f32 v24, v24, v28
    v_add_f32 v17, v17, v21
    v_add_f32 v25, v25, v29
    v_add_f32 v18, v18, v22
    v_add_f32 v26, v26, v30
    v_add_f32 v19, v19, v23
    v_add_f32 v27, v27, v31
    v_add_f32 v16, v16, v24
    v_add_f32 v17, v17, v25
    v_add_f32 v18, v18, v26
    v_add_f32 v19, v19, v27
    v_xor_b32 v4, 0x80000000, v123
    v_ashrrev_i32 v6, 31, v4
    v_and_b32 v6, 0x7fff0000, v6
    v_xor_b32 v4, v4, v6
    v_and_b32 v4, 0xffff0000, v4
    v_mul_f32 v4, 0xbfb8aa3b, v4
    v_exp_f32 v4, v4
    v_lshlrev_b32 v104, 16, v100
    v_add_f32 v4, 1.0, v4
    v_and_b32 v105, 0xffff0000, v100
    v_rcp_f32 v4, v4
    v_lshlrev_b32 v106, 16, v101
    v_and_b32 v107, 0xffff0000, v101
    v_cvt_pk_bf16_f32 v4, v4, v4
    v_and_b32 v4, 0xffff0000, v4
    v_cvt_pk_bf16_f32 v17, v16, v17
    v_cvt_pk_bf16_f32 v19, v18, v19
    v_lshlrev_b32 v16, 16, v17
    v_and_b32 v17, 0xffff0000, v17
    v_lshlrev_b32 v18, 16, v19
    v_and_b32 v19, 0xffff0000, v19
    v_mul_f32 v16, v16, v4
    v_mul_f32 v17, v17, v4
    v_mul_f32 v18, v18, v4
    v_mul_f32 v19, v19, v4
    v_cvt_pk_bf16_f32 v17, v16, v17
    v_cvt_pk_bf16_f32 v19, v18, v19
    v_lshlrev_b32 v16, 16, v17
    v_and_b32 v17, 0xffff0000, v17
    v_lshlrev_b32 v18, 16, v19
    v_and_b32 v19, 0xffff0000, v19
    v_add_f32 v16, v16, v104
    v_add_f32 v17, v17, v105
    v_add_f32 v18, v18, v106
    v_add_f32 v19, v19, v107
    v_cvt_pk_bf16_f32 v17, v16, v17
    v_cvt_pk_bf16_f32 v19, v18, v19
    v_lshlrev_b32 v16, 16, v17
    v_and_b32 v17, 0xffff0000, v17
    v_lshlrev_b32 v18, 16, v19
    v_and_b32 v19, 0xffff0000, v19
    v_mul_f32 v108, 0xbfb8aa3b, v16
    v_mul_f32 v109, 0xbfb8aa3b, v17
    v_mul_f32 v110, 0xbfb8aa3b, v18
    v_mul_f32 v111, 0xbfb8aa3b, v19
    v_exp_f32 v108, v108
    v_exp_f32 v109, v109
    v_exp_f32 v110, v110
    v_exp_f32 v111, v111
    v_add_f32 v108, 1.0, v108
    v_add_f32 v109, 1.0, v109
    v_add_f32 v110, 1.0, v110
    v_add_f32 v111, 1.0, v111
    v_rcp_f32 v108, v108
    v_rcp_f32 v109, v109
    v_rcp_f32 v110, v110
    v_rcp_f32 v111, v111
    v_mul_f32 v16, v16, v108
    v_mul_f32 v17, v17, v109
    v_mul_f32 v18, v18, v110
    v_mul_f32 v19, v19, v111
    v_min_u32 v16, -2, v16
    v_min_u32 v17, -2, v17
    v_min_u32 v18, -2, v18
    v_min_u32 v19, -2, v19
    v_lshlrev_b32 v7, 4, v5
    v_lshl_add_u32 v6, v117, 9, v7
    s_lshl_b32 s46, s49, 6
    s_add_u32 s46, s46, 0xa10000
    s_mov_b32 exec_lo, 0x00ff00ff
    s_mov_b32 exec_hi, 0x00ff00ff
    buffer_store_dwordx4 v[16:19], v6, s[4:7], s46 offen sc1
    s_mov_b64 exec, -1
k2_gate:
    s_mov_b32 s32, s20
    s_mov_b32 s33, s21
    s_lshl_b32 s41, s28, 7
    s_lshl_b32 s38, s24, 17
    s_add_u32 s38, s38, s41
    v_lshlrev_b32 v5, 10, v8
    s_add_u32 s42, s38, 65536
    buffer_load_dword v6, v5, s[32:35], s38 offen
    buffer_load_dword v7, v5, s[32:35], s42 offen
    s_lshl_b32 s38, s24, 13
    s_add_u32 s38, s38, s41
    s_lshl_b32 s39, s24, 10
    s_add_u32 s39, s39, 65536
    v_lshlrev_b32 v10, 2, v8
    v_and_b32 v10, 64, v10
    v_xor_b32 v10, v118, v10
    s_lshl_b32 s45, s27, 12
    s_add_u32 s43, s45, 0xa60000
    v_and_b32 v11, 31, v8
    v_lshlrev_b32 v11, 7, v11
    v_lshrrev_b32 v12, 5, v8
    s_mov_b32 s45, 0x40000
    v_mad_u32_u24 v11, v12, s45, v11
    s_waitcnt vmcnt(0)
    s_cmp_lt_u32 s26, 28
    s_cbranch_scc0 k2_nolong
    s_sleep 64
k2_nolong:
    v_mov_b32 v2, 0
k2_lw_27:
    ds_read_b128 v[4:7], v2 offset:32
    ds_read_b128 v[12:15], v2 offset:48
    s_waitcnt lgkmcnt(0)
    v_min3_u32 v4, v4, v5, v6
    v_min3_u32 v4, v4, v7, v12
    v_min3_u32 v4, v4, v13, v14
    v_min_u32 v4, v4, v15
    s_nop 0
    v_readfirstlane_b32 s45, v4
    s_cmp_ge_u32 s45, 6
    s_cbranch_scc1 k2_lg_28
    s_sleep 32
    s_branch k2_lw_27
k2_lg_28:
    s_cmp_eq_u32 s24, 0
    s_cbranch_scc0 k2_marked
    s_mov_b32 s48, 0
k2_mpoll:
    buffer_load_dword v6, v11, s[4:7], s43 offen sc1
    s_waitcnt vmcnt(0)
    v_cmp_ne_u32 vcc, s97, v6
    s_cbranch_vccz k2_marked
    s_sleep 8
    s_add_u32 s48, s48, 1
    s_cmp_lt_u32 s48, 262144
    s_cbranch_scc1 k2_mpoll
k2_marked:
    s_add_u32 m0, s39, 0
    s_add_u32 s42, s38, 0
    buffer_load_dwordx4 v10, s[32:35], s42 offen lds
    s_add_u32 m0, s39, 4096
    s_add_u32 s42, s38, 32768
    buffer_load_dwordx4 v10, s[32:35], s42 offen lds
    s_add_u32 m0, s39, 8192
    s_add_u32 s42, s38, 65536
    buffer_load_dwordx4 v10, s[32:35], s42 offen lds
    s_add_u32 m0, s39, 12288
    s_add_u32 s42, s38, 98304
    buffer_load_dwordx4 v10, s[32:35], s42 offen lds
    s_add_u32 m0, s39, 16384
    s_add_u32 s42, s38, 131072
    buffer_load_dwordx4 v10, s[32:35], s42 offen lds
    s_add_u32 m0, s39, 20480
    s_add_u32 s42, s38, 163840
    buffer_load_dwordx4 v10, s[32:35], s42 offen lds
    s_add_u32 m0, s39, 24576
    s_add_u32 s42, s38, 196608
    buffer_load_dwordx4 v10, s[32:35], s42 offen lds
    s_add_u32 m0, s39, 28672
    s_add_u32 s42, s38, 229376
    buffer_load_dwordx4 v10, s[32:35], s42 offen lds
    s_add_u32 m0, s39, 32768
    s_add_u32 s42, s38, 262144
    buffer_load_dwordx4 v10, s[32:35], s42 offen lds
    s_add_u32 m0, s39, 36864
    s_add_u32 s42, s38, 294912
    buffer_load_dwordx4 v10, s[32:35], s42 offen lds
    s_add_u32 m0, s39, 40960
    s_add_u32 s42, s38, 327680
    buffer_load_dwordx4 v10, s[32:35], s42 offen lds
    s_add_u32 m0, s39, 45056
    s_add_u32 s42, s38, 360448
    buffer_load_dwordx4 v10, s[32:35], s42 offen lds
    s_add_u32 m0, s39, 49152
    s_add_u32 s42, s38, 393216
    buffer_load_dwordx4 v10, s[32:35], s42 offen lds
    s_add_u32 m0, s39, 53248
    s_add_u32 s42, s38, 425984
    buffer_load_dwordx4 v10, s[32:35], s42 offen lds
    s_add_u32 m0, s39, 57344
    s_add_u32 s42, s38, 458752
    buffer_load_dwordx4 v10, s[32:35], s42 offen lds
    s_add_u32 m0, s39, 61440
    s_add_u32 s42, s38, 491520
    buffer_load_dwordx4 v10, s[32:35], s42 offen lds
    s_waitcnt vmcnt(0)
    v_lshl_add_u32 v2, s24, 2, 0
    v_mov_b32 v3, 99
    ds_write_b32 v2, v3 offset:16
    s_sleep 32
    v_mov_b32 v2, 0
k2_lw_29:
    ds_read_b128 v[4:7], v2 offset:32
    ds_read_b128 v[12:15], v2 offset:48
    s_waitcnt lgkmcnt(0)
    v_min3_u32 v4, v4, v5, v6
    v_min3_u32 v4, v4, v7, v12
    v_min3_u32 v4, v4, v13, v14
    v_min_u32 v4, v4, v15
    s_nop 0
    v_readfirstlane_b32 s45, v4
    s_cmp_ge_u32 s45, 9
    s_cbranch_scc1 k2_lg_30
    s_sleep 32
    s_branch k2_lw_29
k2_lg_30:
k2_tail:
    s_mov_b64 s[8:9], s[92:93]
    s_mov_b32 s10, 0x200000
    s_mov_b32 s11, 0x20000
    s_mov_b64 s[12:13], s[88:89]
    s_mov_b32 s14, 0x200000
    s_mov_b32 s15, 0x20000
    s_lshl_b32 s50, s27, 6
    s_lshl_b32 s51, s24, 3
    s_add_u32 s50, s50, s51
    s_lshl_b32 s51, s50, 10
    s_lshl_b32 s52, s28, 7
    s_add_u32 s51, s51, s52
    s_add_u32 s53, s51, 0x800000
    buffer_load_dwordx4 v[88:91], v118, s[4:7], s53 offen sc1
    buffer_load_dwordx4 v[80:83], v118, s[8:11], s51 offen
    v_readlane_b32 s56, v123, 0
    v_readlane_b32 s57, v123, 1
    v_readlane_b32 s58, v123, 2
    v_readlane_b32 s59, v123, 3
    v_readlane_b32 s60, v123, 4
    v_readlane_b32 s61, v123, 5
    v_readlane_b32 s62, v123, 6
    v_readlane_b32 s63, v123, 7
    v_lshrrev_b32 v2, 3, v8
    v_and_b32 v3, 7, v8
    v_lshlrev_b32 v96, 5, v3
    s_sub_u32 s43, 0x7ff, s50
    v_sub_u32 v15, s43, v2
    s_mov_b64 s[44:45], 0
    s_and_b32 s48, s56, 0x7ff
    v_cmp_eq_u32 vcc, s48, v15
    v_add_u32 v97, 0, v96
    s_or_b64 s[44:45], s[44:45], vcc
    v_cndmask_b32 v96, v96, v97, vcc
    s_and_b32 s48, s57, 0x7ff
    v_cmp_eq_u32 vcc, s48, v15
    v_add_u32 v97, 2048, v96
    s_or_b64 s[44:45], s[44:45], vcc
    v_cndmask_b32 v96, v96, v97, vcc
    s_and_b32 s48, s58, 0x7ff
    v_cmp_eq_u32 vcc, s48, v15
    v_add_u32 v97, 4096, v96
    s_or_b64 s[44:45], s[44:45], vcc
    v_cndmask_b32 v96, v96, v97, vcc
    s_and_b32 s48, s59, 0x7ff
    v_cmp_eq_u32 vcc, s48, v15
    v_add_u32 v97, 6144, v96
    s_or_b64 s[44:45], s[44:45], vcc
    v_cndmask_b32 v96, v96, v97, vcc
    s_and_b32 s48, s60, 0x7ff
    v_cmp_eq_u32 vcc, s48, v15
    v_add_u32 v97, 8192, v96
    s_or_b64 s[44:45], s[44:45], vcc
    v_cndmask_b32 v96, v96, v97, vcc
    s_and_b32 s48, s61, 0x7ff
    v_cmp_eq_u32 vcc, s48, v15
    v_add_u32 v97, 10240, v96
    s_or_b64 s[44:45], s[44:45], vcc
    v_cndmask_b32 v96, v96, v97, vcc
    s_and_b32 s48, s62, 0x7ff
    v_cmp_eq_u32 vcc, s48, v15
    v_add_u32 v97, 12288, v96
    s_or_b64 s[44:45], s[44:45], vcc
    v_cndmask_b32 v96, v96, v97, vcc
    s_and_b32 s48, s63, 0x7ff
    v_cmp_eq_u32 vcc, s48, v15
    v_add_u32 v97, 14336, v96
    s_or_b64 s[44:45], s[44:45], vcc
    v_cndmask_b32 v96, v96, v97, vcc
    v_lshl_add_u32 v11, s24, 3, v2
    v_lshlrev_b32 v11, 8, v11
    v_lshlrev_b32 v10, 1, v3
    v_xor_b32 v10, v10, v2
    v_lshl_add_u32 v11, v10, 4, v11
    v_add_u32 v11, 131072, v11
    v_xor_b32 v10, 16, v11
    s_waitcnt vmcnt(0)
    v_lshlrev_b32 v16, 16, v88
    v_and_b32 v17, 0xffff0000, v88
    v_lshlrev_b32 v18, 16, v89
    v_and_b32 v19, 0xffff0000, v89
    v_lshlrev_b32 v20, 16, v90
    v_and_b32 v21, 0xffff0000, v90
    v_lshlrev_b32 v22, 16, v91
    v_and_b32 v23, 0xffff0000, v91
    v_mul_f32 v32, 0xbfb8aa3b, v16
    v_mul_f32 v33, 0xbfb8aa3b, v17
    v_mul_f32 v34, 0xbfb8aa3b, v18
    v_mul_f32 v35, 0xbfb8aa3b, v19
    v_mul_f32 v36, 0xbfb8aa3b, v20
    v_mul_f32 v37, 0xbfb8aa3b, v21
    v_mul_f32 v38, 0xbfb8aa3b, v22
    v_mul_f32 v39, 0xbfb8aa3b, v23
    v_exp_f32 v32, v32
    v_exp_f32 v33, v33
    v_exp_f32 v34, v34
    v_exp_f32 v35, v35
    v_exp_f32 v36, v36
    v_exp_f32 v37, v37
    v_exp_f32 v38, v38
    v_exp_f32 v39, v39
    v_add_f32 v32, 1.0, v32
    v_add_f32 v33, 1.0, v33
    v_add_f32 v34, 1.0, v34
    v_add_f32 v35, 1.0, v35
    v_add_f32 v36, 1.0, v36
    v_add_f32 v37, 1.0, v37
    v_add_f32 v38, 1.0, v38
    v_add_f32 v39, 1.0, v39
    v_rcp_f32 v32, v32
    v_rcp_f32 v33, v33
    v_rcp_f32 v34, v34
    v_rcp_f32 v35, v35
    v_rcp_f32 v36, v36
    v_rcp_f32 v37, v37
    v_rcp_f32 v38, v38
    v_rcp_f32 v39, v39
    v_mul_f32 v16, v16, v32
    v_mul_f32 v17, v17, v33
    v_mul_f32 v18, v18, v34
    v_mul_f32 v19, v19, v35
    v_mul_f32 v20, v20, v36
    v_mul_f32 v21, v21, v37
    v_mul_f32 v22, v22, v38
    v_mul_f32 v23, v23, v39
    v_lshlrev_b32 v64, 16, v80
    v_and_b32 v65, 0xffff0000, v80
    v_lshlrev_b32 v66, 16, v81
    v_and_b32 v67, 0xffff0000, v81
    v_lshlrev_b32 v68, 16, v82
    v_and_b32 v69, 0xffff0000, v82
    v_lshlrev_b32 v70, 16, v83
    v_and_b32 v71, 0xffff0000, v83
    s_lshl_b32 s48, s28, 8
    s_add_u32 s48, s48, 0xa10000
    s_cmp_eq_u64 s[44:45], 0
    s_cbranch_scc1 k2_nosel
    s_mov_b64 exec, s[44:45]
    s_mov_b32 s49, 0
k2_gpoll:
    buffer_load_dwordx4 v[16:19], v96, s[4:7], s48 offen sc1
    buffer_load_dwordx4 v[20:23], v96, s[4:7], s48 offen offset:16 sc1
    s_add_u32 s49, s49, 1
    s_waitcnt vmcnt(0)
    v_max3_u32 v4, v16, v17, v18
    v_max3_u32 v4, v19, v20, v4
    v_max3_u32 v4, v21, v22, v4
    v_max_u32 v4, v23, v4
    v_cmp_eq_u32 vcc, -1, v4
    s_cmp_lt_u32 s49, 262144
    s_cselect_b64 vcc, vcc, 0
    s_cbranch_vccnz k2_gpoll
    s_mov_b64 exec, -1
k2_nosel:
    s_barrier
    ds_read_b128 v[32:35], v11 offset:0
    ds_read_b128 v[36:39], v10 offset:0
    ds_read_b128 v[40:43], v11 offset:16384
    ds_read_b128 v[44:47], v10 offset:16384
    s_waitcnt lgkmcnt(0)
    v_add_f32 v32, v32, v40
    v_add_f32 v33, v33, v41
    v_add_f32 v34, v34, v42
    v_add_f32 v35, v35, v43
    v_add_f32 v36, v36, v44
    v_add_f32 v37, v37, v45
    v_add_f32 v38, v38, v46
    v_add_f32 v39, v39, v47
    v_fmac_f32 v64, v32, v16
    v_fmac_f32 v65, v33, v17
    v_fmac_f32 v66, v34, v18
    v_fmac_f32 v67, v35, v19
    v_fmac_f32 v68, v36, v20
    v_fmac_f32 v69, v37, v21
    v_fmac_f32 v70, v38, v22
    v_fmac_f32 v71, v39, v23
    v_cvt_pk_bf16_f32 v96, v64, v65
    v_cvt_pk_bf16_f32 v97, v66, v67
    v_cvt_pk_bf16_f32 v98, v68, v69
    v_cvt_pk_bf16_f32 v99, v70, v71
    buffer_store_dwordx4 v[96:99], v118, s[12:15], s51 offen sc1
    s_endpgm
code_end:
.section .rodata,"a"
.p2align 6
desc_start:
.p2align 6
.amdhsa_kernel recurrent_scan__mha_block__moe_arch_mod__prompt_kernel
  .amdhsa_next_free_vgpr 168
  .amdhsa_next_free_sgpr 102
  .amdhsa_accum_offset 168
  .amdhsa_group_segment_fixed_size 0
  .amdhsa_kernarg_size 88
  .amdhsa_user_sgpr_count 2
  .amdhsa_user_sgpr_kernarg_segment_ptr 1
  .amdhsa_system_sgpr_workgroup_id_x 1
  .amdhsa_float_denorm_mode_32 3
.end_amdhsa_kernel
```
